```python
import torch

def _softmax(x, axis=-1):
    return torch.softmax(x, dim=axis)

def _gelu(x):
    return torch.nn.functional.gelu(x, approximate='tanh')

def _silu(x):
    return torch.nn.functional.silu(x)

def _sigmoid(x):
    return torch.sigmoid(x)

def _layernorm(x, axis=-1, eps=1e-05):
    m = x.mean(dim=axis, keepdim=True)
    v = x.var(dim=axis, keepdim=True, unbiased=False)
    return (x - m) / torch.sqrt(v + eps)

def _scatter_add(tgt, idx, src, axis=0):
    return tgt.clone().index_add_(axis, idx, src)

def _segment_sum(src, seg, n):
    out = torch.zeros((n,) + src.shape[1:], dtype=src.dtype)
    return out.index_add_(0, seg, src)

def _pad(x, pw):
    flat = tuple((v for pair in reversed(pw) for v in pair))
    return torch.nn.functional.pad(x, flat)
kernel_name = 'adaLN_cond__ssm_conv_h3__moe_arch_mod__prompt'

def setup_inputs():

    _w = lambda a: (lambda t: t.to(torch.bfloat16) if t.is_floating_point() else t)(torch.as_tensor(a))

    def _A_setup():
        B, S, D = (1, 2048, 512)
        ks = 4
        return {'q': _w((lambda *s: torch.randn(*s, dtype=torch.bfloat16) * 0.1)(B, S, D)), 'k': _w((lambda *s: torch.randn(*s, dtype=torch.bfloat16) * 3.2)(B, S, D)), 'v': _w((lambda *s: torch.randn(*s, dtype=torch.bfloat16) * 3.2)(B, S, D)), 'shift_k': _w((lambda *s: torch.randn(*s, dtype=torch.bfloat16) * 3.2)(D, ks) * 0.5), 'ssm_k': _w((lambda *s: torch.randn(*s, dtype=torch.bfloat16) * 3.2)(D, S) * (1.0 / S ** 0.5)), 'ssm_D': _w((lambda *s: torch.randn(*s, dtype=torch.bfloat16) * 3.2)(D))}
    _A_in = _A_setup()

    def _B_setup():
        B, S, D, F, C = (1, 2048, 512, 1792, 8)
        return {'x': _w((lambda *s: torch.randn(*s, dtype=torch.bfloat16) * 0.1)(B, S, D)), 'w_r': _w((lambda *s: torch.randn(*s, dtype=torch.bfloat16) * 0.4)(D)), 'w_gate': _w((lambda *s: torch.randn(*s, dtype=torch.bfloat16) * 0.4)(D, F)), 'w_up': _w((lambda *s: torch.randn(*s, dtype=torch.bfloat16) * 0.4)(D, F)), 'w_down': _w((lambda *s: torch.randn(*s, dtype=torch.bfloat16) * 0.4)(F, D))}
    _B_in = _B_setup()
    return {'A_q': _A_in['q'], 'A_k': _A_in['k'], 'A_v': _A_in['v'], 'A_shift_k': _A_in['shift_k'], 'A_ssm_k': _A_in['ssm_k'], 'A_ssm_D': _A_in['ssm_D'], 'B_x': _B_in['x'], 'B_w_r': _B_in['w_r'], 'B_w_gate': _B_in['w_gate'], 'B_w_up': _B_in['w_up'], 'B_w_down': _B_in['w_down'], 'c': _w((lambda *s: torch.randn(*s, dtype=torch.bfloat16) * 0.2)(1, 512) * 8.0), 'w_mod': _w((lambda *s: torch.randn(*s, dtype=torch.bfloat16) * 0.2)(512, 6 * 512) * 512 ** (-0.5) * 8.0)}

def reference(A_q, A_k, A_v, A_shift_k, A_ssm_k, A_ssm_D, B_x, B_w_r, B_w_gate, B_w_up, B_w_down, c, w_mod):

    def _A_ref(q, k, v, shift_k, ssm_k, ssm_D):
        B, S, D = q.shape
        ks = shift_k.shape[-1]
        k_pad = _pad(k, ((0, 0), (ks - 1, 0), (0, 0)))
        k_shift = torch.zeros_like(k)
        for t in range(ks):
            k_shift = k_shift + k_pad[:, t:t + S, :] * shift_k[:, ks - 1 - t][None, None, :]
        kv = k_shift * v
        L = 2 * S
        kv_pad = _pad(kv, ((0, 0), (0, S), (0, 0)))
        kf_pad = _pad(ssm_k, ((0, 0), (0, S)))
        kv_f = (lambda x, axes=(-2, -1): torch.fft.rfft2(x.float(), dim=axes))(kv_pad[:, None, :, :], axes=(1, 2))
        kf_f = (lambda x, axes=(-2, -1): torch.fft.rfft2(x.float(), dim=axes))(kf_pad[:, None, :], axes=(1, 2))
        kf_f = (lambda x, *d: x.permute(*d))(kf_f, 1, 2, 0)
        y_f = kv_f * kf_f[None, :, :, :]
        y = (lambda x, s, axes=(-2, -1): torch.fft.irfft2(x, s=s, dim=axes).to(torch.bfloat16))(y_f, (1, L), axes=(1, 2))[:, 0, :S, :]
        y = y + kv * ssm_D[None, None, :]
        return q * y

    def _B_ref(x, w_r, w_gate, w_up, w_down):
        B, S, D = x.shape
        C = 8
        r = x @ w_r
        idx = torch.argsort(-r, axis=-1)[:, :C]
        idx_e = (lambda x, n, axis: torch.repeat_interleave(x, n, dim=axis))(idx.reshape(B, C, 1), D, axis=2)
        x_sel = (lambda x, i, axis: torch.take_along_dim(x, i, dim=axis))(x, idx_e, axis=1)
        g = _silu(x_sel @ w_gate)
        u = x_sel @ w_up
        y = g * u @ w_down
        r_sel = _sigmoid((lambda x, i, axis: torch.take_along_dim(x, i, dim=axis))(r, idx, axis=1))
        y = y * r_sel.reshape(B, C, 1)
        b_off = (torch.arange(B) * S).reshape(B, 1)
        flat_idx = (idx + b_off).reshape(B * C)
        zero = (x * 0.0).reshape(B * S, D)
        upd = _scatter_add(zero, flat_idx, y.reshape(B * C, D), axis=0)
        return x + upd.reshape(B, S, D)
    x = A_q
    mod = (_silu(c) @ w_mod).reshape(c.shape[0], 6, 1, -1)
    sa, ca, ga, sb, cb, gb = (mod[:, 0].clone(), mod[:, 1].clone(), mod[:, 2].clone(), mod[:, 3].clone(), mod[:, 4].clone(), mod[:, 5].clone())
    h = _layernorm(x, axis=-1) * (1 + ca) + sa
    x = x + ga * _A_ref(h, A_k, A_v, A_shift_k, A_ssm_k, A_ssm_D)
    h = _layernorm(x, axis=-1) * (1 + cb) + sb
    x = x + gb * _B_ref(h, B_w_r, B_w_gate, B_w_up, B_w_down)
    return x
```

```asm
; @launch grid=(256,1,1) block=(640,1,1) lds=152064
.amdgcn_target "amdgcn-amd-amdhsa--gfx950"
.text
.p2align 8
.globl adaLN_cond__ssm_conv_h3__moe_arch_mod__prompt_kernel
.type adaLN_cond__ssm_conv_h3__moe_arch_mod__prompt_kernel,@function
adaLN_cond__ssm_conv_h3__moe_arch_mod__prompt_kernel:
    s_load_dwordx16 s[16:31], s[0:1], 0
    s_cmp_ge_u32 s2, 256
    s_cbranch_scc1 k_exit
    v_lshrrev_b32 v1, 6, v0
    s_and_b32 s4, s2, 7
    v_readfirstlane_b32 s7, v1
    s_lshr_b32 s5, s2, 3
    v_and_b32 v1, 63, v0
    s_cmp_ge_u32 s7, 8
    s_cbranch_scc1 k_aux
    v_lshrrev_b32 v3, 5, v1
    s_lshl_b32 s8, s7, 1
    s_add_u32 s8, s8, 2
    v_add_u32 v4, s8, v3
    v_xor_b32 v4, v4, v1
    v_and_b32 v4, 7, v4
    v_lshrrev_b32 v5, 3, v1
    v_lshlrev_b32 v5, 10, v5
    v_lshl_add_u32 v4, v4, 4, v5
    s_lshl_b32 s8, s5, 16
    s_lshl_b32 s9, s4, 7
    s_add_u32 s8, s8, s9
    s_lshl_b32 s9, s7, 13
    s_add_u32 s9, s9, s8
    s_lshl_b32 s10, s7, 10
    s_add_u32 s10, s10, 27648
    s_mov_b32 m0, s10
    s_add_u32 s10, s10, 9216
    s_mov_b32 s50, 0x200000
    s_mov_b32 s51, 0x00020000
    s_mov_b32 s54, 0x200000
    s_mov_b32 s55, 0x00020000
    v_lshrrev_b32 v6, 4, v1
    s_lshl_b32 s11, s4, 9
    s_lshl_b32 s64, s7, 6
    s_add_u32 s11, s11, s64
    v_lshl_add_u32 v7, v6, 4, s11
    s_waitcnt lgkmcnt(0)
    s_mov_b64 s[48:49], s[18:19]
    s_mov_b64 s[52:53], s[20:21]
    buffer_load_dwordx4 v4, s[48:51], s9 offen lds
    s_memrealtime s[28:29]
    s_mov_b32 m0, s10
    s_cmp_ge_u32 s7, 2
    buffer_load_dwordx4 v4, s[52:55], s9 offen lds
    global_load_dwordx4 v[36:39], v7, s[22:23]
    s_cbranch_scc1 k_nohalo
    v_xor_b32 v4, v3, v1
    v_and_b32 v4, 7, v4
    v_lshl_add_u32 v4, v4, 4, v5
    s_sub_u32 s8, s8, 8192
    s_cmp_eq_u32 s5, 0
    s_cselect_b32 s8, 0x80000000, s8
    s_cmp_eq_u32 s7, 0
    s_cbranch_scc0 k_halov
    s_mov_b32 m0, 26624
    s_nop 0
    buffer_load_dwordx4 v4, s[48:51], s8 offen lds
    s_branch k_nohalo
k_halov:
    s_mov_b32 m0, 35840
    s_nop 0
    buffer_load_dwordx4 v4, s[52:55], s8 offen lds
k_nohalo:
    s_load_dwordx16 s[32:47], s[0:1], 64
    s_mov_b32 s3, 0xffff0000
    s_lshl_b32 s6, s4, 5
    s_add_u32 s6, s6, s5
    v_lshlrev_b32 v2, 4, v1
    s_lshl_b32 s12, s6, 3
    s_add_u32 s12, s12, s7
    s_lshl_b32 s13, s12, 10
    s_lshl_b32 s64, s6, 2
    s_load_dword s69, s[26:27], s64
    s_barrier
    v_and_b32 v8, 15, v1
    v_sub_u32 v9, 15, v8
    v_lshlrev_b32 v10, 9, v9
    v_lshl_add_u32 v10, v6, 2, v10
    v_add_u32 v11, 1, v9
    v_xor_b32 v11, s7, v11
    v_and_b32 v11, 7, v11
    v_lshl_add_u32 v11, v11, 4, v10
    v_add_u32 v11, 27136, v11
    v_add_u32 v12, 2, v9
    v_xor_b32 v12, s7, v12
    v_and_b32 v12, 7, v12
    v_lshl_add_u32 v12, v12, 4, v10
    v_add_u32 v12, 27648, v12
    v_lshlrev_b32 v13, 14, v6
    v_lshl_add_u32 v13, v8, 4, v13
    s_lshl_b32 s60, s4, 19
    s_lshl_b32 s9, s7, 16
    s_add_u32 s60, s60, s9
    s_lshl_b32 s9, s5, 8
    s_sub_u32 s60, s60, s9
    s_add_u32 s60, s60, 7936
    s_add_u32 s61, s60, 8192
    v_mov_b32 v4, 0
    v_mov_b32 v5, 0
    v_mov_b32 v6, 0
    v_mov_b32 v7, 0
    v_mov_b32 v8, 1
    s_waitcnt lgkmcnt(0)
    s_add_u32 s56, s46, 0xf000000
    s_addc_u32 s57, s47, 0
    s_mov_b32 s58, 0x900000
    s_mov_b32 s59, 0x00020000
    s_and_b32 s8, s7, 1
    s_lshr_b32 s9, s7, 1
    s_and_b32 s9, s9, 1
    s_mul_i32 s10, s8, 17664
    s_add_u32 s10, s10, 59392
    s_lshl_b32 s11, s6, 1
    s_add_u32 s11, s11, s8
    s_lshl_b32 s11, s11, 12
    s_lshl_b32 s66, s9, 2
    s_add_u32 s66, s66, s11
    s_mul_i32 s67, s9, 4224
    s_add_u32 s67, s67, s10
    s_add_u32 s67, s67, 9216
    s_add_u32 s64, s67, 64
    s_mov_b32 m0, s64
    s_mov_b32 s52, s24
    s_mov_b32 s53, s25
    s_mov_b32 s54, 0x200000
    s_mov_b32 s55, 0x00020000
    s_sub_u32 s28, s28, 400
    s_lshl_b32 s29, s29, 16
    s_or_b32 s29, s29, 0x80000000
    s_waitcnt vmcnt(0)
    s_mov_b64 exec, 1
    ds_add_u32 v4, v8 offset:648
    s_mov_b64 exec, -1
    s_memrealtime s[14:15]
    v_lshlrev_b32 v44, 16, v36
    v_and_b32 v46, s3, v36
    v_lshlrev_b32 v48, 16, v37
    v_and_b32 v50, s3, v37
    v_lshlrev_b32 v45, 16, v38
    v_and_b32 v47, s3, v38
    v_lshlrev_b32 v49, 16, v39
    v_and_b32 v51, s3, v39
    s_mov_b32 s64, 0
lw0:
    ds_read_b32 v14, v4 offset:648
    s_add_u32 s64, s64, 1
    s_waitcnt lgkmcnt(0)
    v_readfirstlane_b32 s65, v14
    s_nop 0
    s_cmp_ge_u32 s65, 8
    s_cbranch_scc1 lw0_ok
    s_cmp_lt_u32 s64, 262144
    s_cbranch_scc1 lw0
lw0_ok:
    ds_read_b32 v16, v11 offset:0
    ds_read_b32 v17, v11 offset:128
    ds_read_b32 v18, v11 offset:256
    ds_read_b32 v19, v11 offset:384
    ds_read_b32 v20, v12 offset:0
    ds_read_b32 v21, v12 offset:128
    ds_read_b32 v22, v12 offset:256
    ds_read_b32 v23, v12 offset:384
    ds_read_b32 v24, v11 offset:9600
    ds_read_b32 v25, v12 offset:9216
    ds_read_b32 v26, v12 offset:9344
    ds_read_b32 v27, v12 offset:9472
    ds_read_b32 v28, v12 offset:9600
    s_cmp_lt_u32 s7, 4
    s_cbranch_scc1 k_nokdma
    buffer_load_dwordx4 v2, s[52:55], s66 offen offset:0 lds
    buffer_load_dwordx4 v2, s[52:55], s66 offen offset:1024 lds
    buffer_load_dwordx4 v2, s[52:55], s66 offen offset:2048 lds
    buffer_load_dwordx4 v2, s[52:55], s66 offen offset:3072 lds
    buffer_load_dword v9, v4, s[52:55], s11 offen
k_nokdma:
    s_lshl_b32 s15, s15, 16
    s_or_b32 s15, s15, 0x80000000
    s_waitcnt lgkmcnt(12)
    v_lshlrev_b32 v60, 16, v16
    v_and_b32 v61, s3, v16
    s_waitcnt lgkmcnt(11)
    v_lshlrev_b32 v62, 16, v17
    v_and_b32 v63, s3, v17
    s_waitcnt lgkmcnt(10)
    v_lshlrev_b32 v64, 16, v18
    v_and_b32 v65, s3, v18
    s_waitcnt lgkmcnt(9)
    v_lshlrev_b32 v66, 16, v19
    v_and_b32 v67, s3, v19
    s_waitcnt lgkmcnt(8)
    v_lshlrev_b32 v68, 16, v20
    v_and_b32 v69, s3, v20
    s_waitcnt lgkmcnt(7)
    v_lshlrev_b32 v70, 16, v21
    v_and_b32 v71, s3, v21
    s_waitcnt lgkmcnt(6)
    v_lshlrev_b32 v72, 16, v22
    v_and_b32 v73, s3, v22
    s_waitcnt lgkmcnt(5)
    v_lshlrev_b32 v74, 16, v23
    v_and_b32 v75, s3, v23
    v_pk_mul_f32 v[80:81], v[60:61], v[50:51]
    v_pk_mul_f32 v[82:83], v[62:63], v[50:51]
    v_pk_mul_f32 v[84:85], v[64:65], v[50:51]
    v_pk_mul_f32 v[86:87], v[66:67], v[50:51]
    v_pk_mul_f32 v[88:89], v[68:69], v[50:51]
    v_cvt_pk_bf16_f32 v80, 0, v80
    v_cvt_pk_bf16_f32 v81, 0, v81
    v_cvt_pk_bf16_f32 v82, 0, v82
    v_cvt_pk_bf16_f32 v83, 0, v83
    v_cvt_pk_bf16_f32 v84, 0, v84
    v_cvt_pk_bf16_f32 v85, 0, v85
    v_cvt_pk_bf16_f32 v86, 0, v86
    v_cvt_pk_bf16_f32 v87, 0, v87
    v_cvt_pk_bf16_f32 v88, 0, v88
    v_cvt_pk_bf16_f32 v89, 0, v89
    v_pk_mul_f32 v[92:93], v[62:63], v[48:49]
    v_pk_mul_f32 v[94:95], v[64:65], v[48:49]
    v_pk_mul_f32 v[96:97], v[66:67], v[48:49]
    v_pk_mul_f32 v[98:99], v[68:69], v[48:49]
    v_pk_mul_f32 v[100:101], v[70:71], v[48:49]
    v_cvt_pk_bf16_f32 v92, 0, v92
    v_cvt_pk_bf16_f32 v93, 0, v93
    v_cvt_pk_bf16_f32 v94, 0, v94
    v_cvt_pk_bf16_f32 v95, 0, v95
    v_cvt_pk_bf16_f32 v96, 0, v96
    v_cvt_pk_bf16_f32 v97, 0, v97
    v_cvt_pk_bf16_f32 v98, 0, v98
    v_cvt_pk_bf16_f32 v99, 0, v99
    v_cvt_pk_bf16_f32 v100, 0, v100
    v_cvt_pk_bf16_f32 v101, 0, v101
    v_pk_add_f32 v[80:81], v[80:81], v[92:93]
    v_pk_add_f32 v[82:83], v[82:83], v[94:95]
    v_pk_add_f32 v[84:85], v[84:85], v[96:97]
    v_pk_add_f32 v[86:87], v[86:87], v[98:99]
    v_pk_add_f32 v[88:89], v[88:89], v[100:101]
    v_cvt_pk_bf16_f32 v80, 0, v80
    v_cvt_pk_bf16_f32 v81, 0, v81
    v_cvt_pk_bf16_f32 v82, 0, v82
    v_cvt_pk_bf16_f32 v83, 0, v83
    v_cvt_pk_bf16_f32 v84, 0, v84
    v_cvt_pk_bf16_f32 v85, 0, v85
    v_cvt_pk_bf16_f32 v86, 0, v86
    v_cvt_pk_bf16_f32 v87, 0, v87
    v_cvt_pk_bf16_f32 v88, 0, v88
    v_cvt_pk_bf16_f32 v89, 0, v89
    v_pk_mul_f32 v[92:93], v[64:65], v[46:47]
    v_pk_mul_f32 v[94:95], v[66:67], v[46:47]
    v_pk_mul_f32 v[96:97], v[68:69], v[46:47]
    v_pk_mul_f32 v[98:99], v[70:71], v[46:47]
    v_pk_mul_f32 v[100:101], v[72:73], v[46:47]
    v_cvt_pk_bf16_f32 v92, 0, v92
    v_cvt_pk_bf16_f32 v93, 0, v93
    v_cvt_pk_bf16_f32 v94, 0, v94
    v_cvt_pk_bf16_f32 v95, 0, v95
    v_cvt_pk_bf16_f32 v96, 0, v96
    v_cvt_pk_bf16_f32 v97, 0, v97
    v_cvt_pk_bf16_f32 v98, 0, v98
    v_cvt_pk_bf16_f32 v99, 0, v99
    v_cvt_pk_bf16_f32 v100, 0, v100
    v_cvt_pk_bf16_f32 v101, 0, v101
    v_pk_add_f32 v[80:81], v[80:81], v[92:93]
    v_pk_add_f32 v[82:83], v[82:83], v[94:95]
    v_pk_add_f32 v[84:85], v[84:85], v[96:97]
    v_pk_add_f32 v[86:87], v[86:87], v[98:99]
    v_pk_add_f32 v[88:89], v[88:89], v[100:101]
    v_cvt_pk_bf16_f32 v80, 0, v80
    v_cvt_pk_bf16_f32 v81, 0, v81
    v_cvt_pk_bf16_f32 v82, 0, v82
    v_cvt_pk_bf16_f32 v83, 0, v83
    v_cvt_pk_bf16_f32 v84, 0, v84
    v_cvt_pk_bf16_f32 v85, 0, v85
    v_cvt_pk_bf16_f32 v86, 0, v86
    v_cvt_pk_bf16_f32 v87, 0, v87
    v_cvt_pk_bf16_f32 v88, 0, v88
    v_cvt_pk_bf16_f32 v89, 0, v89
    v_pk_mul_f32 v[92:93], v[66:67], v[44:45]
    v_pk_mul_f32 v[94:95], v[68:69], v[44:45]
    v_pk_mul_f32 v[96:97], v[70:71], v[44:45]
    v_pk_mul_f32 v[98:99], v[72:73], v[44:45]
    v_pk_mul_f32 v[100:101], v[74:75], v[44:45]
    v_cvt_pk_bf16_f32 v92, 0, v92
    v_cvt_pk_bf16_f32 v93, 0, v93
    v_cvt_pk_bf16_f32 v94, 0, v94
    v_cvt_pk_bf16_f32 v95, 0, v95
    v_cvt_pk_bf16_f32 v96, 0, v96
    v_cvt_pk_bf16_f32 v97, 0, v97
    v_cvt_pk_bf16_f32 v98, 0, v98
    v_cvt_pk_bf16_f32 v99, 0, v99
    v_cvt_pk_bf16_f32 v100, 0, v100
    v_cvt_pk_bf16_f32 v101, 0, v101
    v_pk_add_f32 v[80:81], v[80:81], v[92:93]
    v_pk_add_f32 v[82:83], v[82:83], v[94:95]
    v_pk_add_f32 v[84:85], v[84:85], v[96:97]
    v_pk_add_f32 v[86:87], v[86:87], v[98:99]
    v_pk_add_f32 v[88:89], v[88:89], v[100:101]
    v_cvt_pk_bf16_f32 v80, 0, v80
    v_cvt_pk_bf16_f32 v81, 0, v81
    v_cvt_pk_bf16_f32 v82, 0, v82
    v_cvt_pk_bf16_f32 v83, 0, v83
    v_cvt_pk_bf16_f32 v84, 0, v84
    v_cvt_pk_bf16_f32 v85, 0, v85
    v_cvt_pk_bf16_f32 v86, 0, v86
    v_cvt_pk_bf16_f32 v87, 0, v87
    v_cvt_pk_bf16_f32 v88, 0, v88
    v_cvt_pk_bf16_f32 v89, 0, v89
    s_waitcnt lgkmcnt(4)
    v_lshlrev_b32 v92, 16, v24
    v_and_b32 v93, s3, v24
    s_waitcnt lgkmcnt(3)
    v_lshlrev_b32 v94, 16, v25
    v_and_b32 v95, s3, v25
    s_waitcnt lgkmcnt(2)
    v_lshlrev_b32 v96, 16, v26
    v_and_b32 v97, s3, v26
    s_waitcnt lgkmcnt(1)
    v_lshlrev_b32 v98, 16, v27
    v_and_b32 v99, s3, v27
    s_waitcnt lgkmcnt(0)
    v_lshlrev_b32 v100, 16, v28
    v_and_b32 v101, s3, v28
    v_pk_mul_f32 v[80:81], v[80:81], v[92:93]
    v_pk_mul_f32 v[82:83], v[82:83], v[94:95]
    v_pk_mul_f32 v[84:85], v[84:85], v[96:97]
    v_pk_mul_f32 v[86:87], v[86:87], v[98:99]
    v_pk_mul_f32 v[88:89], v[88:89], v[100:101]
    v_cvt_pk_bf16_f32 v104, v88, v86
    v_cvt_pk_bf16_f32 v105, v84, v82
    v_cvt_pk_bf16_f32 v106, v80, 0
    v_cvt_pk_bf16_f32 v108, v89, v87
    v_cvt_pk_bf16_f32 v109, v85, v83
    v_cvt_pk_bf16_f32 v110, v81, 0
    v_mov_b32 v107, s14
    v_or_b32 v106, s15, v106
    v_mov_b32 v111, s14
    v_or_b32 v110, s15, v110
    buffer_store_dwordx4 v[104:107], v13, s[56:59], s60 offen sc1
    buffer_store_dwordx4 v[108:111], v13, s[56:59], s61 offen sc1
    s_mov_b64 exec, 1
    ds_add_u32 v4, v8 offset:660
    s_mov_b64 exec, -1
    s_cmp_ge_u32 s7, 4
    s_cbranch_scc1 k_helper
    s_mul_i32 s11, s9, 4576
    s_add_u32 s11, s11, s10
    v_add_u32 v3, s11, v2
    s_mov_b32 exec_lo, 0x0fffffff
    s_mov_b32 exec_hi, 0
    ds_write_b128 v3, v[4:7] offset:4096
    s_mov_b64 exec, -1
    v_and_b32 v10, 15, v1
    v_lshrrev_b32 v11, 4, v1
    v_lshrrev_b32 v12, 1, v10
    v_and_b32 v13, 1, v10
    v_lshlrev_b32 v3, 6, v12
    v_lshl_add_u32 v3, v11, 4, v3
    v_mul_u32_u24 v4, 4576, v13
    v_add_u32 v3, v3, v4
    s_lshl_b32 s64, s9, 8
    s_sub_u32 s65, s10, s64
    s_add_u32 s65, s65, 5328
    v_sub_u32 v3, s65, v3
    v_lshlrev_b32 v4, 3, v12
    v_lshlrev_b32 v5, 4, v11
    v_sub_u32 v4, v4, v5
    v_mul_u32_u24 v5, 4216, v13
    v_sub_u32 v4, v4, v5
    s_sub_u32 s65, s10, s64
    s_add_u32 s65, s65, 13744
    v_add_u32 v4, s65, v4
    v_lshlrev_b32 v5, 8, v11
    v_lshl_add_u32 v5, v10, 3, v5
    s_lshl_b32 s64, s8, 1
    s_add_u32 s64, s64, s9
    s_lshl_b32 s64, s64, 13
    s_add_u32 s64, s64, 26624
    v_add_u32 v5, s64, v5
    v_mov_b32 v7, 1
    s_waitcnt vmcnt(0)
    s_mov_b64 exec, 1
    ds_add_u32 v6, v7 offset:656
    s_mov_b64 exec, -1
    s_sleep 12
    v_lshlrev_b32 v48, 4, v0
    s_lshl_b32 s8, s6, 14
    s_add_u32 s9, s8, 8192
    v_lshlrev_b32 v49, 3, v0
    v_add_u32 v49, 59392, v49
    s_mov_b32 s64, 0
uf0:
    buffer_load_dwordx4 v[40:43], v48, s[56:59], s8 offen sc1
    buffer_load_dwordx4 v[44:47], v48, s[56:59], s9 offen sc1
    s_waitcnt vmcnt(0)
    v_subrev_u32 v50, s28, v43
    v_subrev_u32 v51, s28, v47
    v_xor_b32 v52, s29, v42
    v_xor_b32 v53, s29, v46
    v_max_u32 v50, v50, v51
    v_or_b32 v52, v52, v53
    v_and_or_b32 v50, v52, s3, v50
    v_cmp_le_u32 vcc, 2048, v50
    s_add_u32 s64, s64, 1
    s_and_b64 exec, exec, vcc
    s_cbranch_execz uf0_done
    s_cmp_lt_u32 s64, 20
    s_cbranch_scc1 uf0
    s_branch uf0_more
uf0_done:
    s_mov_b64 exec, -1
    ds_write_b64 v49, v[40:41] offset:0
    v_alignbit_b32 v50, v41, v40, 16
    v_alignbit_b32 v51, v42, v41, 16
    ds_write_b64 v49, v[50:51] offset:4576
    ds_write_b64 v49, v[44:45] offset:17664
    v_alignbit_b32 v52, v45, v44, 16
    v_alignbit_b32 v53, v46, v45, 16
    ds_write_b64 v49, v[52:53] offset:22240
    s_waitcnt lgkmcnt(0)
    s_mov_b64 exec, 1
    ds_add_u32 v6, v7 offset:652
    s_mov_b64 exec, -1
    s_mov_b32 s64, 0
lw1:
    ds_read_b32 v8, v6 offset:652
    s_add_u32 s64, s64, 1
    s_waitcnt lgkmcnt(0)
    v_readfirstlane_b32 s65, v8
    s_nop 0
    s_cmp_ge_u32 s65, 8
    s_cbranch_scc1 lw1_ok
    s_cmp_lt_u32 s64, 262144
    s_cbranch_scc1 lw1
lw1_ok:
    s_setprio 2
    ds_read_b128 v[40:43], v3 offset:3776
    ds_read_b64 v[72:73], v4 offset:192
    ds_read_b64 v[74:75], v4 offset:200
    ds_read_b128 v[44:47], v3 offset:3264
    ds_read_b64 v[76:77], v4 offset:704
    ds_read_b64 v[78:79], v4 offset:712
    ds_read_b128 v[48:51], v3 offset:2752
    ds_read_b64 v[80:81], v4 offset:1216
    ds_read_b64 v[82:83], v4 offset:1224
    ds_read_b128 v[52:55], v3 offset:2240
    ds_read_b64 v[84:85], v4 offset:1728
    ds_read_b64 v[86:87], v4 offset:1736
    ds_read_b128 v[56:59], v3 offset:1728
    ds_read_b64 v[88:89], v4 offset:2240
    ds_read_b64 v[90:91], v4 offset:2248
    ds_read_b128 v[60:63], v3 offset:1216
    ds_read_b64 v[92:93], v4 offset:2752
    ds_read_b64 v[94:95], v4 offset:2760
    ds_read_b128 v[64:67], v3 offset:704
    ds_read_b64 v[96:97], v4 offset:3264
    ds_read_b64 v[98:99], v4 offset:3272
    ds_read_b128 v[68:71], v3 offset:192
    ds_read_b64 v[100:101], v4 offset:3776
    ds_read_b64 v[102:103], v4 offset:3784
    s_waitcnt lgkmcnt(15)
    v_mfma_f32_16x16x32_bf16 v[8:11], v[40:43], v[72:75], 0
    v_mfma_f32_16x16x32_bf16 v[12:15], v[44:47], v[72:75], 0
    v_mfma_f32_16x16x32_bf16 v[12:15], v[40:43], v[76:79], v[12:15]
    v_mfma_f32_16x16x32_bf16 v[16:19], v[44:47], v[76:79], 0
    v_mfma_f32_16x16x32_bf16 v[16:19], v[48:51], v[72:75], v[16:19]
    v_mfma_f32_16x16x32_bf16 v[16:19], v[40:43], v[80:83], v[16:19]
    v_mfma_f32_16x16x32_bf16 v[20:23], v[48:51], v[76:79], 0
    v_mfma_f32_16x16x32_bf16 v[20:23], v[44:47], v[80:83], v[20:23]
    v_mfma_f32_16x16x32_bf16 v[24:27], v[48:51], v[80:83], 0
    s_waitcnt lgkmcnt(14)
    v_mfma_f32_16x16x32_bf16 v[20:23], v[52:55], v[72:75], v[20:23]
    s_waitcnt lgkmcnt(12)
    v_mfma_f32_16x16x32_bf16 v[20:23], v[40:43], v[84:87], v[20:23]
    v_mfma_f32_16x16x32_bf16 v[24:27], v[52:55], v[76:79], v[24:27]
    v_mfma_f32_16x16x32_bf16 v[24:27], v[44:47], v[84:87], v[24:27]
    ds_read_b128 v[104:107], v3 offset:3712
    v_mfma_f32_16x16x32_bf16 v[28:31], v[52:55], v[80:83], 0
    ds_read_b64 v[136:137], v4 offset:128
    ds_read_b64 v[138:139], v4 offset:136
    v_mfma_f32_16x16x32_bf16 v[28:31], v[48:51], v[84:87], v[28:31]
    ds_read_b128 v[108:111], v3 offset:3200
    v_mfma_f32_16x16x32_bf16 v[32:35], v[52:55], v[84:87], 0
    ds_read_b64 v[140:141], v4 offset:640
    ds_read_b64 v[142:143], v4 offset:648
    s_waitcnt lgkmcnt(15)
    v_mfma_f32_16x16x32_bf16 v[24:27], v[56:59], v[72:75], v[24:27]
    ds_read_b128 v[112:115], v3 offset:2688
    v_mfma_f32_16x16x32_bf16 v[24:27], v[40:43], v[88:91], v[24:27]
    ds_read_b64 v[144:145], v4 offset:1152
    ds_read_b64 v[146:147], v4 offset:1160
    v_mfma_f32_16x16x32_bf16 v[28:31], v[56:59], v[76:79], v[28:31]
    ds_read_b128 v[116:119], v3 offset:2176
    v_mfma_f32_16x16x32_bf16 v[28:31], v[44:47], v[88:91], v[28:31]
    ds_read_b64 v[148:149], v4 offset:1664
    ds_read_b64 v[150:151], v4 offset:1672
    v_mfma_f32_16x16x32_bf16 v[32:35], v[56:59], v[80:83], v[32:35]
    ds_read_b128 v[120:123], v3 offset:1664
    v_mfma_f32_16x16x32_bf16 v[32:35], v[48:51], v[88:91], v[32:35]
    ds_read_b64 v[152:153], v4 offset:2176
    ds_read_b64 v[154:155], v4 offset:2184
    v_mfma_f32_16x16x32_bf16 v[36:39], v[56:59], v[84:87], 0
    ds_read_b128 v[124:127], v3 offset:1152
    v_mfma_f32_16x16x32_bf16 v[36:39], v[52:55], v[88:91], v[36:39]
    ds_read_b64 v[156:157], v4 offset:2688
    ds_read_b64 v[158:159], v4 offset:2696
    s_waitcnt lgkmcnt(15)
    v_mfma_f32_16x16x32_bf16 v[28:31], v[60:63], v[72:75], v[28:31]
    ds_read_b128 v[128:131], v3 offset:640
    v_mfma_f32_16x16x32_bf16 v[28:31], v[40:43], v[92:95], v[28:31]
    ds_read_b64 v[160:161], v4 offset:3200
    ds_read_b64 v[162:163], v4 offset:3208
    v_mfma_f32_16x16x32_bf16 v[32:35], v[60:63], v[76:79], v[32:35]
    ds_read_b128 v[132:135], v3 offset:128
    v_mfma_f32_16x16x32_bf16 v[32:35], v[44:47], v[92:95], v[32:35]
    ds_read_b64 v[164:165], v4 offset:3712
    ds_read_b64 v[166:167], v4 offset:3720
    v_mfma_f32_16x16x32_bf16 v[36:39], v[60:63], v[80:83], v[36:39]
    v_mfma_f32_16x16x32_bf16 v[36:39], v[48:51], v[92:95], v[36:39]
    v_mfma_f32_16x16x32_bf16 v[32:35], v[64:67], v[72:75], v[32:35]
    v_mfma_f32_16x16x32_bf16 v[32:35], v[40:43], v[96:99], v[32:35]
    v_mfma_f32_16x16x32_bf16 v[36:39], v[64:67], v[76:79], v[36:39]
    v_mfma_f32_16x16x32_bf16 v[36:39], v[44:47], v[96:99], v[36:39]
    v_mfma_f32_16x16x32_bf16 v[36:39], v[68:71], v[72:75], v[36:39]
    v_mfma_f32_16x16x32_bf16 v[36:39], v[40:43], v[100:103], v[36:39]
    s_waitcnt lgkmcnt(0)
    v_mfma_f32_16x16x32_bf16 v[8:11], v[104:107], v[136:139], v[8:11]
    ds_read_b128 v[40:43], v3 offset:3648
    v_mfma_f32_16x16x32_bf16 v[12:15], v[108:111], v[136:139], v[12:15]
    ds_read_b64 v[72:73], v4 offset:64
    ds_read_b64 v[74:75], v4 offset:72
    v_mfma_f32_16x16x32_bf16 v[12:15], v[104:107], v[140:143], v[12:15]
    ds_read_b128 v[44:47], v3 offset:3136
    v_mfma_f32_16x16x32_bf16 v[16:19], v[108:111], v[140:143], v[16:19]
    ds_read_b64 v[76:77], v4 offset:576
    ds_read_b64 v[78:79], v4 offset:584
    v_mfma_f32_16x16x32_bf16 v[16:19], v[112:115], v[136:139], v[16:19]
    ds_read_b128 v[48:51], v3 offset:2624
    v_mfma_f32_16x16x32_bf16 v[16:19], v[104:107], v[144:147], v[16:19]
    ds_read_b64 v[80:81], v4 offset:1088
    ds_read_b64 v[82:83], v4 offset:1096
    v_mfma_f32_16x16x32_bf16 v[20:23], v[112:115], v[140:143], v[20:23]
    ds_read_b128 v[52:55], v3 offset:2112
    v_mfma_f32_16x16x32_bf16 v[20:23], v[108:111], v[144:147], v[20:23]
    ds_read_b64 v[84:85], v4 offset:1600
    ds_read_b64 v[86:87], v4 offset:1608
    v_mfma_f32_16x16x32_bf16 v[24:27], v[112:115], v[144:147], v[24:27]
    ds_read_b128 v[56:59], v3 offset:1600
    v_mfma_f32_16x16x32_bf16 v[20:23], v[116:119], v[136:139], v[20:23]
    ds_read_b64 v[88:89], v4 offset:2112
    ds_read_b64 v[90:91], v4 offset:2120
    v_mfma_f32_16x16x32_bf16 v[20:23], v[104:107], v[148:151], v[20:23]
    ds_read_b128 v[60:63], v3 offset:1088
    v_mfma_f32_16x16x32_bf16 v[24:27], v[116:119], v[140:143], v[24:27]
    ds_read_b64 v[92:93], v4 offset:2624
    ds_read_b64 v[94:95], v4 offset:2632
    v_mfma_f32_16x16x32_bf16 v[24:27], v[108:111], v[148:151], v[24:27]
    ds_read_b128 v[64:67], v3 offset:576
    v_mfma_f32_16x16x32_bf16 v[28:31], v[116:119], v[144:147], v[28:31]
    ds_read_b64 v[96:97], v4 offset:3136
    ds_read_b64 v[98:99], v4 offset:3144
    v_mfma_f32_16x16x32_bf16 v[28:31], v[112:115], v[148:151], v[28:31]
    ds_read_b128 v[68:71], v3 offset:64
    v_mfma_f32_16x16x32_bf16 v[32:35], v[116:119], v[148:151], v[32:35]
    ds_read_b64 v[100:101], v4 offset:3648
    ds_read_b64 v[102:103], v4 offset:3656
    v_mfma_f32_16x16x32_bf16 v[24:27], v[120:123], v[136:139], v[24:27]
    v_mfma_f32_16x16x32_bf16 v[24:27], v[104:107], v[152:155], v[24:27]
    v_mfma_f32_16x16x32_bf16 v[28:31], v[120:123], v[140:143], v[28:31]
    v_mfma_f32_16x16x32_bf16 v[28:31], v[108:111], v[152:155], v[28:31]
    v_mfma_f32_16x16x32_bf16 v[32:35], v[120:123], v[144:147], v[32:35]
    v_mfma_f32_16x16x32_bf16 v[32:35], v[112:115], v[152:155], v[32:35]
    v_mfma_f32_16x16x32_bf16 v[36:39], v[120:123], v[148:151], v[36:39]
    v_mfma_f32_16x16x32_bf16 v[36:39], v[116:119], v[152:155], v[36:39]
    v_mfma_f32_16x16x32_bf16 v[28:31], v[124:127], v[136:139], v[28:31]
    v_mfma_f32_16x16x32_bf16 v[28:31], v[104:107], v[156:159], v[28:31]
    v_mfma_f32_16x16x32_bf16 v[32:35], v[124:127], v[140:143], v[32:35]
    v_mfma_f32_16x16x32_bf16 v[32:35], v[108:111], v[156:159], v[32:35]
    v_mfma_f32_16x16x32_bf16 v[36:39], v[124:127], v[144:147], v[36:39]
    v_mfma_f32_16x16x32_bf16 v[36:39], v[112:115], v[156:159], v[36:39]
    v_mfma_f32_16x16x32_bf16 v[32:35], v[128:131], v[136:139], v[32:35]
    v_mfma_f32_16x16x32_bf16 v[32:35], v[104:107], v[160:163], v[32:35]
    v_mfma_f32_16x16x32_bf16 v[36:39], v[128:131], v[140:143], v[36:39]
    v_mfma_f32_16x16x32_bf16 v[36:39], v[108:111], v[160:163], v[36:39]
    v_mfma_f32_16x16x32_bf16 v[36:39], v[132:135], v[136:139], v[36:39]
    v_mfma_f32_16x16x32_bf16 v[36:39], v[104:107], v[164:167], v[36:39]
    s_waitcnt lgkmcnt(0)
    v_mfma_f32_16x16x32_bf16 v[8:11], v[40:43], v[72:75], v[8:11]
    ds_read_b128 v[104:107], v3 offset:3584
    v_mfma_f32_16x16x32_bf16 v[12:15], v[44:47], v[72:75], v[12:15]
    ds_read_b64 v[136:137], v4 offset:0
    ds_read_b64 v[138:139], v4 offset:8
    v_mfma_f32_16x16x32_bf16 v[12:15], v[40:43], v[76:79], v[12:15]
    ds_read_b128 v[108:111], v3 offset:3072
    v_mfma_f32_16x16x32_bf16 v[16:19], v[44:47], v[76:79], v[16:19]
    ds_read_b64 v[140:141], v4 offset:512
    ds_read_b64 v[142:143], v4 offset:520
    v_mfma_f32_16x16x32_bf16 v[16:19], v[48:51], v[72:75], v[16:19]
    ds_read_b128 v[112:115], v3 offset:2560
    v_mfma_f32_16x16x32_bf16 v[16:19], v[40:43], v[80:83], v[16:19]
    ds_read_b64 v[144:145], v4 offset:1024
    ds_read_b64 v[146:147], v4 offset:1032
    v_mfma_f32_16x16x32_bf16 v[20:23], v[48:51], v[76:79], v[20:23]
    ds_read_b128 v[116:119], v3 offset:2048
    v_mfma_f32_16x16x32_bf16 v[20:23], v[44:47], v[80:83], v[20:23]
    ds_read_b64 v[148:149], v4 offset:1536
    ds_read_b64 v[150:151], v4 offset:1544
    v_mfma_f32_16x16x32_bf16 v[24:27], v[48:51], v[80:83], v[24:27]
    ds_read_b128 v[120:123], v3 offset:1536
    v_mfma_f32_16x16x32_bf16 v[20:23], v[52:55], v[72:75], v[20:23]
    ds_read_b64 v[152:153], v4 offset:2048
    ds_read_b64 v[154:155], v4 offset:2056
    v_mfma_f32_16x16x32_bf16 v[20:23], v[40:43], v[84:87], v[20:23]
    ds_read_b128 v[124:127], v3 offset:1024
    v_mfma_f32_16x16x32_bf16 v[24:27], v[52:55], v[76:79], v[24:27]
    ds_read_b64 v[156:157], v4 offset:2560
    ds_read_b64 v[158:159], v4 offset:2568
    v_mfma_f32_16x16x32_bf16 v[24:27], v[44:47], v[84:87], v[24:27]
    ds_read_b128 v[128:131], v3 offset:512
    v_mfma_f32_16x16x32_bf16 v[28:31], v[52:55], v[80:83], v[28:31]
    ds_read_b64 v[160:161], v4 offset:3072
    ds_read_b64 v[162:163], v4 offset:3080
    v_mfma_f32_16x16x32_bf16 v[28:31], v[48:51], v[84:87], v[28:31]
    ds_read_b128 v[132:135], v3 offset:0
    v_mfma_f32_16x16x32_bf16 v[32:35], v[52:55], v[84:87], v[32:35]
    ds_read_b64 v[164:165], v4 offset:3584
    ds_read_b64 v[166:167], v4 offset:3592
    v_mfma_f32_16x16x32_bf16 v[24:27], v[56:59], v[72:75], v[24:27]
    v_mfma_f32_16x16x32_bf16 v[24:27], v[40:43], v[88:91], v[24:27]
    v_mfma_f32_16x16x32_bf16 v[28:31], v[56:59], v[76:79], v[28:31]
    v_mfma_f32_16x16x32_bf16 v[28:31], v[44:47], v[88:91], v[28:31]
    v_mfma_f32_16x16x32_bf16 v[32:35], v[56:59], v[80:83], v[32:35]
    v_mfma_f32_16x16x32_bf16 v[32:35], v[48:51], v[88:91], v[32:35]
    v_mfma_f32_16x16x32_bf16 v[36:39], v[56:59], v[84:87], v[36:39]
    v_mfma_f32_16x16x32_bf16 v[36:39], v[52:55], v[88:91], v[36:39]
    v_mfma_f32_16x16x32_bf16 v[28:31], v[60:63], v[72:75], v[28:31]
    v_mfma_f32_16x16x32_bf16 v[28:31], v[40:43], v[92:95], v[28:31]
    v_mfma_f32_16x16x32_bf16 v[32:35], v[60:63], v[76:79], v[32:35]
    v_mfma_f32_16x16x32_bf16 v[32:35], v[44:47], v[92:95], v[32:35]
    v_mfma_f32_16x16x32_bf16 v[36:39], v[60:63], v[80:83], v[36:39]
    v_mfma_f32_16x16x32_bf16 v[36:39], v[48:51], v[92:95], v[36:39]
    v_mfma_f32_16x16x32_bf16 v[32:35], v[64:67], v[72:75], v[32:35]
    v_mfma_f32_16x16x32_bf16 v[32:35], v[40:43], v[96:99], v[32:35]
    v_mfma_f32_16x16x32_bf16 v[36:39], v[64:67], v[76:79], v[36:39]
    v_mfma_f32_16x16x32_bf16 v[36:39], v[44:47], v[96:99], v[36:39]
    v_mfma_f32_16x16x32_bf16 v[36:39], v[68:71], v[72:75], v[36:39]
    v_mfma_f32_16x16x32_bf16 v[36:39], v[40:43], v[100:103], v[36:39]
    s_waitcnt lgkmcnt(0)
    v_mfma_f32_16x16x32_bf16 v[8:11], v[104:107], v[136:139], v[8:11]
    v_mfma_f32_16x16x32_bf16 v[12:15], v[108:111], v[136:139], v[12:15]
    v_mfma_f32_16x16x32_bf16 v[12:15], v[104:107], v[140:143], v[12:15]
    v_mfma_f32_16x16x32_bf16 v[16:19], v[108:111], v[140:143], v[16:19]
    v_mfma_f32_16x16x32_bf16 v[16:19], v[112:115], v[136:139], v[16:19]
    v_mfma_f32_16x16x32_bf16 v[16:19], v[104:107], v[144:147], v[16:19]
    v_mfma_f32_16x16x32_bf16 v[20:23], v[112:115], v[140:143], v[20:23]
    v_mfma_f32_16x16x32_bf16 v[20:23], v[108:111], v[144:147], v[20:23]
    v_mfma_f32_16x16x32_bf16 v[20:23], v[116:119], v[136:139], v[20:23]
    ds_write_b64 v5, v[8:9] offset:0
    ds_write_b64 v5, v[10:11] offset:128
    v_mfma_f32_16x16x32_bf16 v[20:23], v[104:107], v[148:151], v[20:23]
    v_mfma_f32_16x16x32_bf16 v[24:27], v[112:115], v[144:147], v[24:27]
    ds_write_b64 v5, v[12:13] offset:1024
    ds_write_b64 v5, v[14:15] offset:1152
    v_mfma_f32_16x16x32_bf16 v[24:27], v[116:119], v[140:143], v[24:27]
    v_mfma_f32_16x16x32_bf16 v[24:27], v[108:111], v[148:151], v[24:27]
    v_mfma_f32_16x16x32_bf16 v[24:27], v[120:123], v[136:139], v[24:27]
    ds_write_b64 v5, v[16:17] offset:2048
    ds_write_b64 v5, v[18:19] offset:2176
    v_mfma_f32_16x16x32_bf16 v[24:27], v[104:107], v[152:155], v[24:27]
    v_mfma_f32_16x16x32_bf16 v[28:31], v[116:119], v[144:147], v[28:31]
    v_mfma_f32_16x16x32_bf16 v[28:31], v[112:115], v[148:151], v[28:31]
    v_mfma_f32_16x16x32_bf16 v[28:31], v[120:123], v[140:143], v[28:31]
    ds_write_b64 v5, v[20:21] offset:3072
    ds_write_b64 v5, v[22:23] offset:3200
    v_mfma_f32_16x16x32_bf16 v[28:31], v[108:111], v[152:155], v[28:31]
    v_mfma_f32_16x16x32_bf16 v[28:31], v[124:127], v[136:139], v[28:31]
    v_mfma_f32_16x16x32_bf16 v[28:31], v[104:107], v[156:159], v[28:31]
    v_mfma_f32_16x16x32_bf16 v[32:35], v[116:119], v[148:151], v[32:35]
    v_mfma_f32_16x16x32_bf16 v[32:35], v[120:123], v[144:147], v[32:35]
    ds_write_b64 v5, v[24:25] offset:4096
    ds_write_b64 v5, v[26:27] offset:4224
    v_mfma_f32_16x16x32_bf16 v[32:35], v[112:115], v[152:155], v[32:35]
    v_mfma_f32_16x16x32_bf16 v[32:35], v[124:127], v[140:143], v[32:35]
    v_mfma_f32_16x16x32_bf16 v[32:35], v[108:111], v[156:159], v[32:35]
    v_mfma_f32_16x16x32_bf16 v[32:35], v[128:131], v[136:139], v[32:35]
    v_mfma_f32_16x16x32_bf16 v[32:35], v[104:107], v[160:163], v[32:35]
    v_mfma_f32_16x16x32_bf16 v[36:39], v[120:123], v[148:151], v[36:39]
    ds_write_b64 v5, v[28:29] offset:5120
    ds_write_b64 v5, v[30:31] offset:5248
    v_mfma_f32_16x16x32_bf16 v[36:39], v[116:119], v[152:155], v[36:39]
    v_mfma_f32_16x16x32_bf16 v[36:39], v[124:127], v[144:147], v[36:39]
    v_mfma_f32_16x16x32_bf16 v[36:39], v[112:115], v[156:159], v[36:39]
    v_mfma_f32_16x16x32_bf16 v[36:39], v[128:131], v[140:143], v[36:39]
    v_mfma_f32_16x16x32_bf16 v[36:39], v[108:111], v[160:163], v[36:39]
    v_mfma_f32_16x16x32_bf16 v[36:39], v[132:135], v[136:139], v[36:39]
    v_mfma_f32_16x16x32_bf16 v[36:39], v[104:107], v[164:167], v[36:39]
    ds_write_b64 v5, v[32:33] offset:6144
    ds_write_b64 v5, v[34:35] offset:6272
    s_nop 5
    ds_write_b64 v5, v[36:37] offset:7168
    ds_write_b64 v5, v[38:39] offset:7296
    s_setprio 0
    s_waitcnt lgkmcnt(0)
    s_mov_b64 exec, 1
    ds_add_u32 v6, v7 offset:672
    s_mov_b64 exec, -1
    s_mov_b32 s64, 0
lw2:
    ds_read_b64 v[12:13], v6 offset:664
    s_add_u32 s64, s64, 1
    s_waitcnt lgkmcnt(0)
    v_readfirstlane_b32 s15, v13
    v_readfirstlane_b32 s14, v12
    s_cmp_lg_u32 s15, 0
    s_cbranch_scc1 lw2_ok
    s_cmp_lt_u32 s64, 262144
    s_cbranch_scc1 lw2
lw2_ok:
    v_lshrrev_b32 v11, 2, v1
    v_lshlrev_b32 v11, 7, v11
    v_and_b32 v12, 3, v1
    v_lshl_add_u32 v11, v12, 4, v11
    s_lshl_b32 s60, s7, 13
    s_add_u32 s60, s60, 8388608
    s_add_u32 s61, s60, 4096
    buffer_load_dwordx4 v[80:83], v11, s[56:59], s60 offen offset:0 sc1
    buffer_load_dwordx4 v[84:87], v11, s[56:59], s60 offen offset:2048 sc1
    buffer_load_dwordx4 v[88:91], v11, s[56:59], s61 offen offset:0 sc1
    buffer_load_dwordx4 v[92:95], v11, s[56:59], s61 offen offset:2048 sc1
    s_mul_i32 s9, s7, 1536
    v_lshlrev_b32 v12, 3, v1
    v_add_u32 v12, s9, v12
k_epi:
    s_lshl_b32 s64, s7, 10
    v_add_u32 v17, s64, v2
    v_lshrrev_b32 v18, 1, v17
    v_sub_u32 v18, 63480, v18
    s_lshl_b32 s10, s6, 13
    s_add_u32 s10, s10, 4194304
    s_waitcnt lgkmcnt(0)
    s_lshl_b32 s8, s69, 16
    s_and_b32 s9, s69, s3
    v_mov_b32 v16, 0
    s_mov_b32 s64, 0
lw7:
    ds_read_b32 v19, v16 offset:672
    s_add_u32 s64, s64, 1
    s_waitcnt lgkmcnt(0)
    v_readfirstlane_b32 s65, v19
    s_nop 0
    s_cmp_ge_u32 s65, 4
    s_cbranch_scc1 lw7_ok
    s_cmp_lt_u32 s64, 262144
    s_cbranch_scc1 lw7
lw7_ok:
    ds_read_b64 v[20:21], v18
    ds_read_b64 v[22:23], v18 offset:17664
    ds_read_b128 v[32:35], v17 offset:26624
    ds_read_b128 v[36:39], v17 offset:34816
    ds_read_b128 v[40:43], v17 offset:43008
    ds_read_b128 v[44:47], v17 offset:51200
    s_waitcnt lgkmcnt(5)
    v_and_b32 v48, s3, v21
    v_lshlrev_b32 v49, 16, v21
    v_and_b32 v50, s3, v20
    v_lshlrev_b32 v51, 16, v20
    s_waitcnt lgkmcnt(4)
    v_and_b32 v52, s3, v23
    v_lshlrev_b32 v53, 16, v23
    v_and_b32 v54, s3, v22
    v_lshlrev_b32 v55, 16, v22
    v_mul_f32 v48, s8, v48
    v_mul_f32 v49, s8, v49
    v_mul_f32 v50, s8, v50
    v_mul_f32 v51, s8, v51
    v_mul_f32 v52, s9, v52
    v_mul_f32 v53, s9, v53
    v_mul_f32 v54, s9, v54
    v_mul_f32 v55, s9, v55
    v_cvt_pk_bf16_f32 v48, 0, v48
    v_cvt_pk_bf16_f32 v49, 0, v49
    v_cvt_pk_bf16_f32 v50, 0, v50
    v_cvt_pk_bf16_f32 v51, 0, v51
    v_cvt_pk_bf16_f32 v52, 0, v52
    v_cvt_pk_bf16_f32 v53, 0, v53
    v_cvt_pk_bf16_f32 v54, 0, v54
    v_cvt_pk_bf16_f32 v55, 0, v55
    s_waitcnt lgkmcnt(2)
    v_pk_add_f32 v[32:33], v[32:33], v[36:37]
    v_pk_add_f32 v[34:35], v[34:35], v[38:39]
    s_waitcnt lgkmcnt(0)
    v_pk_add_f32 v[40:41], v[40:41], v[44:45]
    v_pk_add_f32 v[42:43], v[42:43], v[46:47]
    v_cvt_pk_bf16_f32 v32, 0, v32
    v_cvt_pk_bf16_f32 v33, 0, v33
    v_cvt_pk_bf16_f32 v34, 0, v34
    v_cvt_pk_bf16_f32 v35, 0, v35
    v_cvt_pk_bf16_f32 v40, 0, v40
    v_cvt_pk_bf16_f32 v41, 0, v41
    v_cvt_pk_bf16_f32 v42, 0, v42
    v_cvt_pk_bf16_f32 v43, 0, v43
    v_pk_add_f32 v[32:33], v[32:33], v[48:49]
    v_pk_add_f32 v[34:35], v[34:35], v[50:51]
    v_pk_add_f32 v[40:41], v[40:41], v[52:53]
    v_pk_add_f32 v[42:43], v[42:43], v[54:55]
    v_cvt_pk_bf16_f32 v56, v32, v40
    v_cvt_pk_bf16_f32 v57, v33, v41
    v_cvt_pk_bf16_f32 v58, v34, v42
    v_cvt_pk_bf16_f32 v59, v35, v43
    v_min_u32 v56, -2, v56
    v_min_u32 v57, -2, v57
    v_min_u32 v58, -2, v58
    v_min_u32 v59, -2, v59
    buffer_store_dwordx4 v[56:59], v17, s[56:59], s10 offen sc1
    s_cmp_ge_u32 s7, 4
    s_cbranch_scc1 k_nomod
    s_waitcnt vmcnt(1)
    v_xor_b32 v48, s14, v82
    v_xor_b32 v49, s15, v83
    v_xor_b32 v50, s14, v86
    v_xor_b32 v51, s15, v87
    v_xor_b32 v52, s14, v90
    v_xor_b32 v53, s15, v91
    v_xor_b32 v54, s14, v94
    v_xor_b32 v55, s15, v95
    v_or3_b32 v48, v48, v49, v50
    v_or3_b32 v51, v51, v52, v53
    v_or3_b32 v48, v48, v54, v55
    v_or_b32 v48, v48, v51
    v_cmp_ne_u32 vcc, 0, v48
    s_nop 0
    s_and_b64 exec, exec, vcc
    s_cbranch_execz k_modok
    s_mov_b32 s64, 0
k_modp:
    buffer_load_dwordx4 v[80:83], v11, s[56:59], s60 offen offset:0 sc1
    buffer_load_dwordx4 v[84:87], v11, s[56:59], s60 offen offset:2048 sc1
    buffer_load_dwordx4 v[88:91], v11, s[56:59], s61 offen offset:0 sc1
    buffer_load_dwordx4 v[92:95], v11, s[56:59], s61 offen offset:2048 sc1
    s_waitcnt vmcnt(0)
    v_xor_b32 v48, s14, v82
    v_xor_b32 v49, s15, v83
    v_xor_b32 v50, s14, v86
    v_xor_b32 v51, s15, v87
    v_xor_b32 v52, s14, v90
    v_xor_b32 v53, s15, v91
    v_xor_b32 v54, s14, v94
    v_xor_b32 v55, s15, v95
    v_or3_b32 v48, v48, v49, v50
    v_or3_b32 v51, v51, v52, v53
    v_or3_b32 v48, v48, v54, v55
    v_or_b32 v48, v48, v51
    v_cmp_ne_u32 vcc, 0, v48
    s_add_u32 s64, s64, 1
    s_and_b64 exec, exec, vcc
    s_cbranch_execz k_modok
    s_cmp_lt_u32 s64, 16384
    s_cbranch_scc1 k_modp
k_modok:
    s_mov_b64 exec, -1
    ds_write_b64 v12, v[80:81] offset:18432
    ds_write_b64 v12, v[88:89] offset:19200
    s_mov_b32 exec_hi, 0
    ds_write_b64 v12, v[84:85] offset:18944
    ds_write_b64 v12, v[92:93] offset:19712
    s_mov_b64 exec, -1
    v_mov_b32 v12, 1
    s_waitcnt lgkmcnt(0)
    s_mov_b64 exec, 1
    ds_add_u32 v16, v12 offset:676
    s_mov_b64 exec, -1
k_nomod:
    s_mov_b32 s64, 0
lw8:
    ds_read_b32 v18, v16 offset:680
    s_add_u32 s64, s64, 1
    s_waitcnt lgkmcnt(0)
    v_readfirstlane_b32 s65, v18
    s_nop 0
    s_cmp_ge_u32 s65, 5
    s_cbranch_scc1 lw8_ok
    s_sleep 1
    s_cmp_lt_u32 s64, 262144
    s_cbranch_scc1 lw8
lw8_ok:
    ds_read_b128 v[12:15], v17 offset:10240
    ds_read_b128 v[20:23], v2 offset:1024
    v_lshrrev_b32 v3, 1, v0
    v_and_b32 v4, 1, v0
    v_lshlrev_b32 v5, 13, v3
    v_lshl_add_u32 v5, v4, 4, v5
    v_mul_u32_u24 v6, 4160, v4
    v_lshl_add_u32 v6, v3, 2, v6
    v_add_u32 v6, 68608, v6
    s_mul_i32 s64, s7, 1040
    s_add_u32 s64, s64, 68608
    v_add_u32 v7, s64, v2
    v_lshlrev_b32 v19, 7, v3
    v_lshl_add_u32 v19, v4, 4, v19
    s_lshl_b32 s11, s6, 5
    s_add_u32 s11, s11, 4194304
    s_waitcnt lgkmcnt(1)
    v_lshlrev_b32 v24, 16, v12
    v_and_b32 v25, s3, v12
    v_lshlrev_b32 v26, 16, v13
    v_and_b32 v27, s3, v13
    v_lshlrev_b32 v28, 16, v14
    v_and_b32 v29, s3, v14
    v_lshlrev_b32 v30, 16, v15
    v_and_b32 v31, s3, v15
    v_readfirstlane_b32 s48, v24
    v_readfirstlane_b32 s49, v24
    s_nop 1
    v_pk_add_f32 v[32:33], v[24:25], s[48:49] neg_lo:[0,1] neg_hi:[0,1]
    v_pk_add_f32 v[34:35], v[26:27], s[48:49] neg_lo:[0,1] neg_hi:[0,1]
    v_pk_add_f32 v[36:37], v[28:29], s[48:49] neg_lo:[0,1] neg_hi:[0,1]
    v_pk_add_f32 v[38:39], v[30:31], s[48:49] neg_lo:[0,1] neg_hi:[0,1]
    v_pk_add_f32 v[60:61], v[32:33], v[34:35]
    v_pk_mul_f32 v[62:63], v[32:33], v[32:33]
    v_pk_add_f32 v[32:33], v[36:37], v[38:39]
    v_pk_fma_f32 v[62:63], v[34:35], v[34:35], v[62:63]
    v_pk_mul_f32 v[34:35], v[36:37], v[36:37]
    v_pk_add_f32 v[60:61], v[60:61], v[32:33]
    v_pk_fma_f32 v[34:35], v[38:39], v[38:39], v[34:35]
    v_add_f32 v60, v60, v61
    v_pk_add_f32 v[62:63], v[62:63], v[34:35]
    v_add_f32 v61, v62, v63
    v_add_f32_dpp v60, v60, v60 row_shr:1 row_mask:0xf bank_mask:0xf
    s_nop 0
    v_add_f32_dpp v61, v61, v61 row_shr:1 row_mask:0xf bank_mask:0xf
    v_add_f32_dpp v60, v60, v60 row_shr:2 row_mask:0xf bank_mask:0xf
    s_nop 0
    v_add_f32_dpp v61, v61, v61 row_shr:2 row_mask:0xf bank_mask:0xf
    v_add_f32_dpp v60, v60, v60 row_shr:4 row_mask:0xf bank_mask:0xf
    s_nop 0
    v_add_f32_dpp v61, v61, v61 row_shr:4 row_mask:0xf bank_mask:0xf
    v_add_f32_dpp v60, v60, v60 row_shr:8 row_mask:0xf bank_mask:0xf
    s_nop 0
    v_add_f32_dpp v61, v61, v61 row_shr:8 row_mask:0xf bank_mask:0xf
    v_add_f32_dpp v60, v60, v60 row_bcast:15 row_mask:0xa bank_mask:0xf
    s_nop 0
    v_add_f32_dpp v61, v61, v61 row_bcast:15 row_mask:0xa bank_mask:0xf
    v_add_f32_dpp v60, v60, v60 row_bcast:31 row_mask:0xc bank_mask:0xf
    s_nop 0
    v_add_f32_dpp v61, v61, v61 row_bcast:31 row_mask:0xc bank_mask:0xf
    v_mul_f32 v60, 0x3b000000, v60
    v_mul_f32 v61, 0x3b000000, v61
    v_fma_f32 v61, -v60, v60, v61
    v_add_f32 v60, s48, v60
    v_max_f32 v61, 0, v61
    v_cvt_pk_bf16_f32 v60, 0, v60
    v_cvt_pk_bf16_f32 v61, 0, v61
    v_readlane_b32 s50, v60, 63
    v_readlane_b32 s51, v60, 63
    v_add_f32 v61, 0x3727c5ac, v61
    v_cvt_pk_bf16_f32 v61, 0, v61
    v_sqrt_f32 v61, v61
    s_nop 0
    v_cvt_pk_bf16_f32 v61, 0, v61
    v_rcp_f32 v61, v61
    v_pk_add_f32 v[40:41], v[24:25], s[50:51] neg_lo:[0,1] neg_hi:[0,1]
    v_pk_add_f32 v[42:43], v[26:27], s[50:51] neg_lo:[0,1] neg_hi:[0,1]
    v_pk_add_f32 v[44:45], v[28:29], s[50:51] neg_lo:[0,1] neg_hi:[0,1]
    v_pk_add_f32 v[46:47], v[30:31], s[50:51] neg_lo:[0,1] neg_hi:[0,1]
    v_cvt_pk_bf16_f32 v40, 0, v40
    v_cvt_pk_bf16_f32 v41, 0, v41
    v_cvt_pk_bf16_f32 v42, 0, v42
    v_cvt_pk_bf16_f32 v43, 0, v43
    v_cvt_pk_bf16_f32 v44, 0, v44
    v_cvt_pk_bf16_f32 v45, 0, v45
    v_cvt_pk_bf16_f32 v46, 0, v46
    v_cvt_pk_bf16_f32 v47, 0, v47
    v_readlane_b32 s52, v61, 63
    v_readlane_b32 s53, v61, 63
    s_nop 1
    v_pk_mul_f32 v[40:41], v[40:41], s[52:53]
    v_pk_mul_f32 v[42:43], v[42:43], s[52:53]
    v_pk_mul_f32 v[44:45], v[44:45], s[52:53]
    v_pk_mul_f32 v[46:47], v[46:47], s[52:53]
    v_cvt_pk_bf16_f32 v40, 0, v40
    v_cvt_pk_bf16_f32 v41, 0, v41
    v_cvt_pk_bf16_f32 v42, 0, v42
    v_cvt_pk_bf16_f32 v43, 0, v43
    v_cvt_pk_bf16_f32 v44, 0, v44
    v_cvt_pk_bf16_f32 v45, 0, v45
    v_cvt_pk_bf16_f32 v46, 0, v46
    v_cvt_pk_bf16_f32 v47, 0, v47
    s_waitcnt lgkmcnt(0)
    v_lshlrev_b32 v112, 16, v20
    v_and_b32 v113, s3, v20
    v_lshlrev_b32 v114, 16, v21
    v_and_b32 v115, s3, v21
    v_lshlrev_b32 v116, 16, v22
    v_and_b32 v117, s3, v22
    v_lshlrev_b32 v118, 16, v23
    v_and_b32 v119, s3, v23
    s_mov_b32 s64, 0
lw9:
    ds_read_b32 v17, v16 offset:676
    s_add_u32 s64, s64, 1
    s_waitcnt lgkmcnt(0)
    v_readfirstlane_b32 s65, v17
    s_nop 0
    s_cmp_ge_u32 s65, 4
    s_cbranch_scc1 lw9_ok
    s_sleep 1
    s_cmp_lt_u32 s64, 262144
    s_cbranch_scc1 lw9
lw9_ok:
    ds_read_b128 v[120:123], v2 offset:18432
    ds_read_b128 v[124:127], v2 offset:19456
    ds_read_b128 v[128:131], v2 offset:20480
    ds_read_b128 v[132:135], v2 offset:21504
    ds_read_b128 v[136:139], v2 offset:22528
    ds_read_b128 v[140:143], v2 offset:23552
    s_waitcnt lgkmcnt(4)
    v_lshlrev_b32 v72, 16, v124
    v_and_b32 v73, s3, v124
    v_lshlrev_b32 v74, 16, v125
    v_and_b32 v75, s3, v125
    v_lshlrev_b32 v76, 16, v126
    v_and_b32 v77, s3, v126
    v_lshlrev_b32 v78, 16, v127
    v_and_b32 v79, s3, v127
    v_lshlrev_b32 v64, 16, v120
    v_and_b32 v65, s3, v120
    v_lshlrev_b32 v66, 16, v121
    v_and_b32 v67, s3, v121
    v_lshlrev_b32 v68, 16, v122
    v_and_b32 v69, s3, v122
    v_lshlrev_b32 v70, 16, v123
    v_and_b32 v71, s3, v123
    v_pk_mul_f32 v[40:41], v[40:41], v[72:73]
    v_pk_mul_f32 v[42:43], v[42:43], v[74:75]
    v_pk_mul_f32 v[44:45], v[44:45], v[76:77]
    v_pk_mul_f32 v[46:47], v[46:47], v[78:79]
    v_cvt_pk_bf16_f32 v40, 0, v40
    v_cvt_pk_bf16_f32 v41, 0, v41
    v_cvt_pk_bf16_f32 v42, 0, v42
    v_cvt_pk_bf16_f32 v43, 0, v43
    v_cvt_pk_bf16_f32 v44, 0, v44
    v_cvt_pk_bf16_f32 v45, 0, v45
    v_cvt_pk_bf16_f32 v46, 0, v46
    v_cvt_pk_bf16_f32 v47, 0, v47
    v_pk_add_f32 v[40:41], v[40:41], v[64:65]
    v_pk_add_f32 v[42:43], v[42:43], v[66:67]
    v_pk_add_f32 v[44:45], v[44:45], v[68:69]
    v_pk_add_f32 v[46:47], v[46:47], v[70:71]
    v_cvt_pk_bf16_f32 v40, 0, v40
    v_cvt_pk_bf16_f32 v41, 0, v41
    v_cvt_pk_bf16_f32 v42, 0, v42
    v_cvt_pk_bf16_f32 v43, 0, v43
    v_cvt_pk_bf16_f32 v44, 0, v44
    v_cvt_pk_bf16_f32 v45, 0, v45
    v_cvt_pk_bf16_f32 v46, 0, v46
    v_cvt_pk_bf16_f32 v47, 0, v47
    s_waitcnt lgkmcnt(3)
    v_lshlrev_b32 v80, 16, v128
    v_and_b32 v81, s3, v128
    v_lshlrev_b32 v82, 16, v129
    v_and_b32 v83, s3, v129
    v_lshlrev_b32 v84, 16, v130
    v_and_b32 v85, s3, v130
    v_lshlrev_b32 v86, 16, v131
    v_and_b32 v87, s3, v131
    s_waitcnt lgkmcnt(2)
    v_lshlrev_b32 v88, 16, v132
    v_and_b32 v89, s3, v132
    v_lshlrev_b32 v90, 16, v133
    v_and_b32 v91, s3, v133
    v_lshlrev_b32 v92, 16, v134
    v_and_b32 v93, s3, v134
    v_lshlrev_b32 v94, 16, v135
    v_and_b32 v95, s3, v135
    s_waitcnt lgkmcnt(1)
    v_lshlrev_b32 v96, 16, v136
    v_and_b32 v97, s3, v136
    v_lshlrev_b32 v98, 16, v137
    v_and_b32 v99, s3, v137
    v_lshlrev_b32 v100, 16, v138
    v_and_b32 v101, s3, v138
    v_lshlrev_b32 v102, 16, v139
    v_and_b32 v103, s3, v139
    s_waitcnt lgkmcnt(0)
    v_lshlrev_b32 v104, 16, v140
    v_and_b32 v105, s3, v140
    v_lshlrev_b32 v106, 16, v141
    v_and_b32 v107, s3, v141
    v_lshlrev_b32 v108, 16, v142
    v_and_b32 v109, s3, v142
    v_lshlrev_b32 v110, 16, v143
    v_and_b32 v111, s3, v143
    s_waitcnt vmcnt(0)
    s_mov_b32 s64, 0
poll2:
    buffer_load_dwordx4 v[12:15], v5, s[56:59], s11 offen sc1
    s_waitcnt vmcnt(0)
    v_max3_u32 v16, v12, v13, v14
    v_max_u32 v16, v16, v15
    v_cmp_eq_u32 vcc, -1, v16
    s_add_u32 s64, s64, 1
    s_and_b64 exec, exec, vcc
    s_cbranch_execz poll2_done
    s_cmp_lt_u32 s64, 16384
    s_cbranch_scc1 poll2
poll2_done:
    s_mov_b64 exec, -1
    ds_write_b32 v6, v12 offset:0
    ds_write_b32 v6, v13 offset:1040
    ds_write_b32 v6, v14 offset:2080
    ds_write_b32 v6, v15 offset:3120
    s_waitcnt lgkmcnt(0)
    s_barrier
    ds_read_b128 v[12:15], v7
    s_waitcnt lgkmcnt(0)
    v_lshlrev_b32 v48, 16, v12
    v_and_b32 v49, s3, v12
    v_lshlrev_b32 v50, 16, v13
    v_and_b32 v51, s3, v13
    v_lshlrev_b32 v52, 16, v14
    v_and_b32 v53, s3, v14
    v_lshlrev_b32 v54, 16, v15
    v_and_b32 v55, s3, v15
    v_pk_mul_f32 v[40:41], v[40:41], v[48:49]
    v_pk_mul_f32 v[42:43], v[42:43], v[50:51]
    v_pk_mul_f32 v[44:45], v[44:45], v[52:53]
    v_pk_mul_f32 v[46:47], v[46:47], v[54:55]
    v_cvt_pk_bf16_f32 v40, 0, v40
    v_cvt_pk_bf16_f32 v41, 0, v41
    v_cvt_pk_bf16_f32 v42, 0, v42
    v_cvt_pk_bf16_f32 v43, 0, v43
    v_cvt_pk_bf16_f32 v44, 0, v44
    v_cvt_pk_bf16_f32 v45, 0, v45
    v_cvt_pk_bf16_f32 v46, 0, v46
    v_cvt_pk_bf16_f32 v47, 0, v47
    v_pk_mul_f32 v[40:41], v[40:41], v[80:81]
    v_pk_mul_f32 v[42:43], v[42:43], v[82:83]
    v_pk_mul_f32 v[44:45], v[44:45], v[84:85]
    v_pk_mul_f32 v[46:47], v[46:47], v[86:87]
    v_cvt_pk_bf16_f32 v40, 0, v40
    v_cvt_pk_bf16_f32 v41, 0, v41
    v_cvt_pk_bf16_f32 v42, 0, v42
    v_cvt_pk_bf16_f32 v43, 0, v43
    v_cvt_pk_bf16_f32 v44, 0, v44
    v_cvt_pk_bf16_f32 v45, 0, v45
    v_cvt_pk_bf16_f32 v46, 0, v46
    v_cvt_pk_bf16_f32 v47, 0, v47
    v_pk_add_f32 v[24:25], v[24:25], v[40:41]
    v_pk_add_f32 v[26:27], v[26:27], v[42:43]
    v_pk_add_f32 v[28:29], v[28:29], v[44:45]
    v_pk_add_f32 v[30:31], v[30:31], v[46:47]
    v_cvt_pk_bf16_f32 v24, 0, v24
    v_cvt_pk_bf16_f32 v25, 0, v25
    v_cvt_pk_bf16_f32 v26, 0, v26
    v_cvt_pk_bf16_f32 v27, 0, v27
    v_cvt_pk_bf16_f32 v28, 0, v28
    v_cvt_pk_bf16_f32 v29, 0, v29
    v_cvt_pk_bf16_f32 v30, 0, v30
    v_cvt_pk_bf16_f32 v31, 0, v31
    v_readfirstlane_b32 s48, v24
    v_readfirstlane_b32 s49, v24
    s_nop 1
    v_pk_add_f32 v[32:33], v[24:25], s[48:49] neg_lo:[0,1] neg_hi:[0,1]
    v_pk_add_f32 v[34:35], v[26:27], s[48:49] neg_lo:[0,1] neg_hi:[0,1]
    v_pk_add_f32 v[36:37], v[28:29], s[48:49] neg_lo:[0,1] neg_hi:[0,1]
    v_pk_add_f32 v[38:39], v[30:31], s[48:49] neg_lo:[0,1] neg_hi:[0,1]
    v_pk_add_f32 v[60:61], v[32:33], v[34:35]
    v_pk_mul_f32 v[62:63], v[32:33], v[32:33]
    v_pk_add_f32 v[32:33], v[36:37], v[38:39]
    v_pk_fma_f32 v[62:63], v[34:35], v[34:35], v[62:63]
    v_pk_mul_f32 v[34:35], v[36:37], v[36:37]
    v_pk_add_f32 v[60:61], v[60:61], v[32:33]
    v_pk_fma_f32 v[34:35], v[38:39], v[38:39], v[34:35]
    v_add_f32 v60, v60, v61
    v_pk_add_f32 v[62:63], v[62:63], v[34:35]
    v_add_f32 v61, v62, v63
    v_add_f32_dpp v60, v60, v60 row_shr:1 row_mask:0xf bank_mask:0xf
    s_nop 0
    v_add_f32_dpp v61, v61, v61 row_shr:1 row_mask:0xf bank_mask:0xf
    v_add_f32_dpp v60, v60, v60 row_shr:2 row_mask:0xf bank_mask:0xf
    s_nop 0
    v_add_f32_dpp v61, v61, v61 row_shr:2 row_mask:0xf bank_mask:0xf
    v_add_f32_dpp v60, v60, v60 row_shr:4 row_mask:0xf bank_mask:0xf
    s_nop 0
    v_add_f32_dpp v61, v61, v61 row_shr:4 row_mask:0xf bank_mask:0xf
    v_add_f32_dpp v60, v60, v60 row_shr:8 row_mask:0xf bank_mask:0xf
    s_nop 0
    v_add_f32_dpp v61, v61, v61 row_shr:8 row_mask:0xf bank_mask:0xf
    v_add_f32_dpp v60, v60, v60 row_bcast:15 row_mask:0xa bank_mask:0xf
    s_nop 0
    v_add_f32_dpp v61, v61, v61 row_bcast:15 row_mask:0xa bank_mask:0xf
    v_add_f32_dpp v60, v60, v60 row_bcast:31 row_mask:0xc bank_mask:0xf
    s_nop 0
    v_add_f32_dpp v61, v61, v61 row_bcast:31 row_mask:0xc bank_mask:0xf
    v_mul_f32 v60, 0x3b000000, v60
    v_mul_f32 v61, 0x3b000000, v61
    v_fma_f32 v61, -v60, v60, v61
    v_add_f32 v60, s48, v60
    v_max_f32 v61, 0, v61
    v_cvt_pk_bf16_f32 v60, 0, v60
    v_cvt_pk_bf16_f32 v61, 0, v61
    v_readlane_b32 s50, v60, 63
    v_readlane_b32 s51, v60, 63
    v_add_f32 v61, 0x3727c5ac, v61
    v_cvt_pk_bf16_f32 v61, 0, v61
    v_sqrt_f32 v61, v61
    s_nop 0
    v_cvt_pk_bf16_f32 v61, 0, v61
    v_rcp_f32 v61, v61
    v_pk_add_f32 v[40:41], v[24:25], s[50:51] neg_lo:[0,1] neg_hi:[0,1]
    v_pk_add_f32 v[42:43], v[26:27], s[50:51] neg_lo:[0,1] neg_hi:[0,1]
    v_pk_add_f32 v[44:45], v[28:29], s[50:51] neg_lo:[0,1] neg_hi:[0,1]
    v_pk_add_f32 v[46:47], v[30:31], s[50:51] neg_lo:[0,1] neg_hi:[0,1]
    v_cvt_pk_bf16_f32 v40, 0, v40
    v_cvt_pk_bf16_f32 v41, 0, v41
    v_cvt_pk_bf16_f32 v42, 0, v42
    v_cvt_pk_bf16_f32 v43, 0, v43
    v_cvt_pk_bf16_f32 v44, 0, v44
    v_cvt_pk_bf16_f32 v45, 0, v45
    v_cvt_pk_bf16_f32 v46, 0, v46
    v_cvt_pk_bf16_f32 v47, 0, v47
    v_readlane_b32 s52, v61, 63
    v_readlane_b32 s53, v61, 63
    s_nop 1
    v_pk_mul_f32 v[40:41], v[40:41], s[52:53]
    v_pk_mul_f32 v[42:43], v[42:43], s[52:53]
    v_pk_mul_f32 v[44:45], v[44:45], s[52:53]
    v_pk_mul_f32 v[46:47], v[46:47], s[52:53]
    v_cvt_pk_bf16_f32 v40, 0, v40
    v_cvt_pk_bf16_f32 v41, 0, v41
    v_cvt_pk_bf16_f32 v42, 0, v42
    v_cvt_pk_bf16_f32 v43, 0, v43
    v_cvt_pk_bf16_f32 v44, 0, v44
    v_cvt_pk_bf16_f32 v45, 0, v45
    v_cvt_pk_bf16_f32 v46, 0, v46
    v_cvt_pk_bf16_f32 v47, 0, v47
    v_pk_mul_f32 v[40:41], v[40:41], v[96:97]
    v_pk_mul_f32 v[42:43], v[42:43], v[98:99]
    v_pk_mul_f32 v[44:45], v[44:45], v[100:101]
    v_pk_mul_f32 v[46:47], v[46:47], v[102:103]
    v_cvt_pk_bf16_f32 v40, 0, v40
    v_cvt_pk_bf16_f32 v41, 0, v41
    v_cvt_pk_bf16_f32 v42, 0, v42
    v_cvt_pk_bf16_f32 v43, 0, v43
    v_cvt_pk_bf16_f32 v44, 0, v44
    v_cvt_pk_bf16_f32 v45, 0, v45
    v_cvt_pk_bf16_f32 v46, 0, v46
    v_cvt_pk_bf16_f32 v47, 0, v47
    v_pk_add_f32 v[40:41], v[40:41], v[88:89]
    v_pk_add_f32 v[42:43], v[42:43], v[90:91]
    v_pk_add_f32 v[44:45], v[44:45], v[92:93]
    v_pk_add_f32 v[46:47], v[46:47], v[94:95]
    v_cvt_pk_bf16_f32 v40, 0, v40
    v_cvt_pk_bf16_f32 v41, 0, v41
    v_cvt_pk_bf16_f32 v42, 0, v42
    v_cvt_pk_bf16_f32 v43, 0, v43
    v_cvt_pk_bf16_f32 v44, 0, v44
    v_cvt_pk_bf16_f32 v45, 0, v45
    v_cvt_pk_bf16_f32 v46, 0, v46
    v_cvt_pk_bf16_f32 v47, 0, v47
    v_pk_mul_f32 v[60:61], v[40:41], v[112:113]
    v_pk_mul_f32 v[62:63], v[42:43], v[114:115]
    v_pk_fma_f32 v[60:61], v[44:45], v[116:117], v[60:61]
    v_pk_fma_f32 v[62:63], v[46:47], v[118:119], v[62:63]
    v_pk_add_f32 v[60:61], v[60:61], v[62:63]
    v_add_f32 v60, v60, v61
    s_nop 1
    v_add_f32_dpp v60, v60, v60 row_shr:1 row_mask:0xf bank_mask:0xf
    s_nop 1
    v_add_f32_dpp v60, v60, v60 row_shr:2 row_mask:0xf bank_mask:0xf
    s_nop 1
    v_add_f32_dpp v60, v60, v60 row_shr:4 row_mask:0xf bank_mask:0xf
    s_nop 1
    v_add_f32_dpp v60, v60, v60 row_shr:8 row_mask:0xf bank_mask:0xf
    s_nop 1
    v_add_f32_dpp v60, v60, v60 row_bcast:15 row_mask:0xa bank_mask:0xf
    s_nop 1
    v_add_f32_dpp v60, v60, v60 row_bcast:31 row_mask:0xc bank_mask:0xf
    v_cvt_pk_bf16_f32 v60, 0, v60
    v_ashrrev_i32 v61, 31, v60
    v_or_b32 v61, 0x80000000, v61
    v_xor_b32 v60, v60, v61
    s_sub_u32 s64, 2047, s12
    v_and_b32 v60, s3, v60
    v_or_b32 v60, s64, v60
    s_lshl_b32 s64, s7, 2
    v_mov_b32 v61, s64
    v_readlane_b32 s14, v60, 63
    s_mov_b32 exec_lo, 0
    s_mov_b32 exec_hi, 0x80000000
    ds_write_b32 v61, v60 offset:32
    s_mov_b64 exec, -1
    s_add_u32 s65, s13, 6291456
    v_and_b32 v61, 1, v1
    v_lshlrev_b32 v61, 4, v61
    s_lshl_b32 s64, s6, 7
    s_add_u32 s64, s64, 8421376
    s_lshl_b32 s65, s6, 11
    s_add_u32 s65, s65, 8519680
    s_waitcnt lgkmcnt(0)
    s_barrier
    ds_read_b128 v[8:11], v61 offset:32
    s_cmp_lg_u32 s7, 0
    s_cbranch_scc1 k_nokey
    s_mov_b64 exec, 0xff
    s_waitcnt lgkmcnt(0)
    buffer_store_dwordx4 v[8:11], v2, s[56:59], s64 offen sc1
    s_mov_b64 exec, -1
k_nokey:
    v_cvt_pk_bf16_f32 v128, v40, v41
    v_cvt_pk_bf16_f32 v129, v42, v43
    v_cvt_pk_bf16_f32 v130, v44, v45
    v_cvt_pk_bf16_f32 v131, v46, v47
    v_cvt_pk_bf16_f32 v124, v24, v25
    v_cvt_pk_bf16_f32 v125, v26, v27
    v_cvt_pk_bf16_f32 v126, v28, v29
    v_cvt_pk_bf16_f32 v127, v30, v31
    v_min_u32 v128, -2, v128
    v_min_u32 v129, -2, v129
    v_min_u32 v130, -2, v130
    v_min_u32 v131, -2, v131
    v_min_u32 v124, -2, v124
    v_min_u32 v125, -2, v125
    v_min_u32 v126, -2, v126
    v_min_u32 v127, -2, v127
    s_waitcnt lgkmcnt(0)
    v_max3_u32 v16, v8, v9, v10
    v_max_u32 v16, v16, v11
    v_cmp_lt_u32 vcc, s14, v16
    s_nop 4
    s_cbranch_vccnz k_nospec
    buffer_store_dwordx4 v[128:131], v2, s[56:59], s65 offen sc1
    buffer_store_dwordx4 v[124:127], v2, s[56:59], s65 offen offset:1024 sc1
k_nospec:
    v_pk_mul_f32 v[32:33], v[40:41], v[104:105]
    v_pk_mul_f32 v[34:35], v[42:43], v[106:107]
    v_pk_mul_f32 v[36:37], v[44:45], v[108:109]
    v_pk_mul_f32 v[38:39], v[46:47], v[110:111]
    v_cvt_pk_bf16_f32 v32, 0, v32
    v_cvt_pk_bf16_f32 v33, 0, v33
    v_cvt_pk_bf16_f32 v34, 0, v34
    v_cvt_pk_bf16_f32 v35, 0, v35
    v_cvt_pk_bf16_f32 v36, 0, v36
    v_cvt_pk_bf16_f32 v37, 0, v37
    v_cvt_pk_bf16_f32 v38, 0, v38
    v_cvt_pk_bf16_f32 v39, 0, v39
    v_pk_add_f32 v[32:33], v[32:33], v[24:25]
    v_pk_add_f32 v[34:35], v[34:35], v[26:27]
    v_pk_add_f32 v[36:37], v[36:37], v[28:29]
    v_pk_add_f32 v[38:39], v[38:39], v[30:31]
    v_cvt_pk_bf16_f32 v120, v32, v33
    v_cvt_pk_bf16_f32 v121, v34, v35
    v_cvt_pk_bf16_f32 v122, v36, v37
    v_cvt_pk_bf16_f32 v123, v38, v39
    v_mov_b32 v20, 0
    v_lshlrev_b32 v21, 2, v1
    v_mov_b32 v16, 0
    v_mov_b32 v17, 0
    v_lshlrev_b32 v18, 3, v1
    ds_write_b64 v18, v[16:17] offset:2560
    ds_write_b64 v18, v[16:17] offset:2048
    v_lshrrev_b32 v24, 3, v1
    v_lshlrev_b32 v24, 6, v24
    v_and_b32 v25, 7, v1
    v_lshl_add_u32 v24, v25, 2, v24
    ds_write_b32 v20, v20 offset:640
    ds_write_b32 v20, v20 offset:644
    s_mov_b32 s11, 8421376
    v_and_b32 v4, 7, v1
    v_lshlrev_b32 v5, 2, v4
    v_lshrrev_b32 v3, 3, v1
    v_add_lshl_u32 v3, v3, v4, 2
    v_and_b32 v3, 28, v3
    v_lshrrev_b32 v6, 4, v1
    v_and_b32 v17, 3, v1
    v_bfe_u32 v18, v1, 2, 2
    v_lshlrev_b32 v22, 7, v6
    v_lshl_add_u32 v22, v18, 4, v22
    v_and_b32 v23, 1, v17
    v_lshl_add_u32 v22, v23, 3, v22
    v_lshrrev_b32 v23, 1, v17
    v_mul_u32_u24 v23, 8256, v23
    v_add_u32 v22, v22, v23
    s_lshl_b32 s64, s7, 10
    s_add_u32 s64, s64, 94720
    v_add_u32 v22, s64, v22
    ds_read_b64_tr_b16 v[72:73], v22 offset:0
    ds_read_b64_tr_b16 v[74:75], v22 offset:64
    ds_read_b64_tr_b16 v[76:77], v22 offset:512
    ds_read_b64_tr_b16 v[78:79], v22 offset:576
    s_lshl_b32 s64, s7, 7
    s_add_u32 s10, s64, 8486912
    v_lshlrev_b32 v23, 11, v4
    s_waitcnt vmcnt(0) lgkmcnt(0)
    s_mov_b32 s64, 0
poll3:
    buffer_load_dwordx4 v[12:15], v19, s[56:59], s11 offen sc1
    s_waitcnt vmcnt(0)
    v_max3_u32 v16, v12, v13, v14
    v_max_u32 v16, v16, v15
    v_cmp_eq_u32 vcc, -1, v16
    s_add_u32 s64, s64, 1
    s_and_b64 exec, exec, vcc
    s_cbranch_execz poll3_done
    s_cmp_lt_u32 s64, 16384
    s_cbranch_scc1 poll3
poll3_done:
    s_mov_b64 exec, -1
    v_max3_u32 v30, v12, v13, v14
    v_max_u32 v30, v30, v15
    s_nop 1
    v_max_u32_dpp v30, v30, v30 row_shr:1 row_mask:0xf bank_mask:0xf
    s_nop 1
    v_max_u32_dpp v30, v30, v30 row_shr:2 row_mask:0xf bank_mask:0xf
    s_nop 1
    v_max_u32_dpp v30, v30, v30 row_shr:4 row_mask:0xf bank_mask:0xf
    s_nop 1
    v_max_u32_dpp v30, v30, v30 row_shr:8 row_mask:0xf bank_mask:0xf
    s_nop 1
    v_max_u32_dpp v30, v30, v30 row_bcast:15 row_mask:0xa bank_mask:0xf
    s_nop 1
    v_max_u32_dpp v30, v30, v30 row_bcast:31 row_mask:0xc bank_mask:0xf
    s_lshl_b32 s64, s7, 2
    v_mov_b32 v31, s64
    s_mov_b32 exec_lo, 0
    s_mov_b32 exec_hi, 0x80000000
    ds_write_b32 v31, v30 offset:0
    s_mov_b64 exec, -1
    s_mov_b32 s15, 0
    v_cmp_lt_u32 s[48:49], s14, v12
    v_cmp_lt_u32 s[50:51], s14, v13
    v_cmp_lt_u32 s[52:53], s14, v14
    v_cmp_lt_u32 s[54:55], s14, v15
    s_bcnt1_i32_b64 s60, s[48:49]
    s_bcnt1_i32_b64 s61, s[50:51]
    s_bcnt1_i32_b64 s62, s[52:53]
    s_bcnt1_i32_b64 s63, s[54:55]
    s_add_u32 s60, s60, s61
    s_add_u32 s62, s62, s63
    s_add_u32 s60, s60, s62
    s_cmp_lt_u32 s60, 8
    s_cbranch_scc1 k_noearly
    s_mov_b32 s48, s42
    s_mov_b32 s49, s43
    s_mov_b32 s50, 0x200000
    s_mov_b32 s51, 0x00020000
    buffer_store_dwordx4 v[120:123], v2, s[48:51], s13 offen sc1
    s_mov_b32 s15, 1
k_noearly:
    s_waitcnt lgkmcnt(0)
    s_barrier
    ds_read_b128 v[34:37], v20 offset:0
    ds_read_b128 v[38:41], v20 offset:16
    s_waitcnt lgkmcnt(1)
    v_min3_u32 v30, v34, v35, v36
    s_waitcnt lgkmcnt(0)
    v_min3_u32 v31, v38, v39, v40
    v_min3_u32 v30, v30, v37, v41
    v_min_u32 v30, v30, v31
    v_cmp_ge_u32 s[48:49], v12, v30
    v_cmp_ge_u32 s[50:51], v13, v30
    v_cmp_ge_u32 s[52:53], v14, v30
    v_cmp_ge_u32 s[54:55], v15, v30
    s_bcnt1_i32_b64 s60, s[48:49]
    s_bcnt1_i32_b64 s61, s[50:51]
    s_bcnt1_i32_b64 s62, s[52:53]
    s_bcnt1_i32_b64 s63, s[54:55]
    s_add_u32 s61, s61, s60
    s_add_u32 s62, s62, s61
    s_add_u32 s63, s63, s62
    s_lshl_b32 s64, s7, 4
    s_cmp_gt_u32 s63, 16
    s_cbranch_scc1 k_tk_over
    v_mbcnt_lo_u32_b32 v34, s48, 0
    v_mbcnt_hi_u32_b32 v34, s49, v34
    v_add_lshl_u32 v34, v34, s64, 2
    v_mbcnt_lo_u32_b32 v35, s50, 0
    v_mbcnt_hi_u32_b32 v35, s51, v35
    s_add_u32 s65, s64, s60
    v_add_lshl_u32 v35, v35, s65, 2
    v_mbcnt_lo_u32_b32 v36, s52, 0
    v_mbcnt_hi_u32_b32 v36, s53, v36
    s_add_u32 s65, s64, s61
    v_add_lshl_u32 v36, v36, s65, 2
    v_mbcnt_lo_u32_b32 v37, s54, 0
    v_mbcnt_hi_u32_b32 v37, s55, v37
    s_add_u32 s65, s64, s62
    v_add_lshl_u32 v37, v37, s65, 2
    s_mov_b64 exec, s[48:49]
    ds_write_b32 v34, v12 offset:2048
    s_mov_b64 exec, s[50:51]
    ds_write_b32 v35, v13 offset:2048
    s_mov_b64 exec, s[52:53]
    ds_write_b32 v36, v14 offset:2048
    s_mov_b64 exec, s[54:55]
    ds_write_b32 v37, v15 offset:2048
    s_mov_b64 exec, -1
    s_cmp_gt_u32 s63, 8
    s_cbranch_scc0 k_tk_b
    v_mov_b32 v34, 1
    ds_or_b32 v20, v34 offset:644
    s_branch k_tk_b
k_tk_over:
    v_mov_b32 v34, 2
    ds_or_b32 v20, v34 offset:644
k_tk_b:
    s_lshl_b32 s64, s7, 6
    v_mov_b32 v31, s64
    s_waitcnt lgkmcnt(0)
    s_barrier
    ds_read_b32 v32, v20 offset:644
    ds_read_b32 v33, v24 offset:2048
    ds_read_b128 v[34:37], v31 offset:2048
    ds_read_b128 v[38:41], v31 offset:2064
    v_mov_b32 v42, 0
    v_mov_b32 v43, 0
    s_waitcnt lgkmcnt(3)
    v_readfirstlane_b32 s64, v32
    s_nop 0
    s_cmp_lg_u32 s64, 0
    s_cbranch_scc1 k_tk_med
    s_waitcnt lgkmcnt(1)
    v_cmp_gt_u32 s[48:49], v34, v33
    v_cmp_gt_u32 s[50:51], v35, v33
    v_cmp_gt_u32 s[52:53], v36, v33
    v_cmp_gt_u32 s[54:55], v37, v33
    v_addc_co_u32 v42, vcc, 0, v42, s[48:49]
    v_addc_co_u32 v43, vcc, 0, v43, s[50:51]
    v_addc_co_u32 v42, vcc, 0, v42, s[52:53]
    v_addc_co_u32 v43, vcc, 0, v43, s[54:55]
    s_waitcnt lgkmcnt(0)
    v_cmp_gt_u32 s[48:49], v38, v33
    v_cmp_gt_u32 s[50:51], v39, v33
    v_cmp_gt_u32 s[52:53], v40, v33
    v_cmp_gt_u32 s[54:55], v41, v33
    v_addc_co_u32 v42, vcc, 0, v42, s[48:49]
    v_addc_co_u32 v43, vcc, 0, v43, s[50:51]
    v_addc_co_u32 v42, vcc, 0, v42, s[52:53]
    v_addc_co_u32 v43, vcc, 0, v43, s[54:55]
    v_add_u32 v42, v42, v43
    ds_add_u32 v21, v42 offset:2560
    v_cmp_ne_u32 s[64:65], 0, v33
    s_waitcnt lgkmcnt(0)
    s_barrier
    ds_read_b32 v42, v21 offset:2560
    s_waitcnt lgkmcnt(0)
    v_cmp_gt_u32 vcc, 8, v42
    v_lshlrev_b32 v42, 2, v42
    s_and_b64 exec, vcc, s[64:65]
    ds_write_b32 v42, v33 offset:64
    s_mov_b64 exec, -1
    s_waitcnt lgkmcnt(0)
k_tk_done:
    ds_read_b32 v7, v5 offset:64
    ds_read_b32 v9, v3 offset:64
    s_waitcnt lgkmcnt(1)
    v_not_b32 v8, v7
    v_and_b32 v8, 0x7ff, v8
    v_and_b32 v10, 0x7f8, v8
    v_lshlrev_b32 v10, 8, v10
    v_add_u32 v10, 32768, v10
    s_waitcnt lgkmcnt(0)
    v_xor_b32 v9, v9, v7
    v_and_b32 v9, 0x7f8, v9
    v_cmp_eq_u32 vcc, 0, v9
    v_lshlrev_b32 v8, 10, v8
    s_andn2_b32 s62, vcc_lo, 0xff
    s_or_b32 s62, s62, vcc_hi
    s_cmp_eq_u32 s62, 0
    s_cselect_b64 s[62:63], -1, 0
    v_cndmask_b32 v10, v23, v10, s[62:63]
    s_cmp_ge_u32 s5, 28
    s_cbranch_scc1 k_ffn2
    v_lshl_add_u32 v9, v6, 4, v10
    s_mov_b32 exec_lo, 0x00ff00ff
    s_mov_b32 exec_hi, 0x00ff00ff
    buffer_load_dwordx4 v[12:15], v9, s[56:59], s10 offen sc1
    buffer_load_dwordx4 v[16:19], v9, s[56:59], s10 offen offset:64 sc1
    s_mov_b64 exec, -1
    v_cmp_eq_u32 vcc, s14, v7
    s_nop 0
    s_and_b32 s60, vcc_lo, 0xff
    s_mov_b32 s48, s42
    s_mov_b32 s49, s43
    s_mov_b32 s50, 0x200000
    s_mov_b32 s51, 0x00020000
    s_andn2_b32 s63, s60, s62
    s_cmp_eq_u32 s63, 0
    s_cbranch_scc1 k_nosela
    s_ff1_i32_b32 s61, s60
    s_lshl_b32 s61, s61, 11
    s_add_u32 s61, s61, 8486912
    buffer_store_dwordx4 v[128:131], v2, s[56:59], s61 offen sc1
    buffer_store_dwordx4 v[124:127], v2, s[56:59], s61 offen offset:1024 sc1
k_nosela:
    s_lshl_b32 s61, s2, 4
    s_add_u32 s61, s61, s7
    s_cmp_lg_u32 s61, 1
    s_cbranch_scc1 k_norst
    s_mov_b32 s52, s44
    s_mov_b32 s53, s45
    s_mov_b32 s54, 0x100
    s_mov_b32 s55, 0x00020000
    v_mov_b32 v20, 0
    v_mov_b32 v21, 0
    s_mov_b64 exec, 1
    buffer_store_dwordx2 v[20:21], v20, s[52:55], 0 offen sc1
k_norst:
    s_mov_b32 exec_lo, 0x00ff00ff
    s_mov_b32 exec_hi, 0x00ff00ff
    s_mov_b32 s64, 0
k_xp:
    s_waitcnt vmcnt(0)
    v_max3_u32 v36, v12, v13, v14
    v_max3_u32 v36, v36, v15, v16
    v_max3_u32 v36, v36, v17, v18
    v_max_u32 v36, v36, v19
    v_cmp_eq_u32 vcc, -1, v36
    s_add_u32 s64, s64, 1
    s_and_b64 exec, exec, vcc
    s_cbranch_execz k_xp_done
    buffer_load_dwordx4 v[12:15], v9, s[56:59], s10 offen sc1
    buffer_load_dwordx4 v[16:19], v9, s[56:59], s10 offen offset:64 sc1
    s_cmp_lt_u32 s64, 16384
    s_cbranch_scc1 k_xp
    s_waitcnt vmcnt(0)
k_xp_done:
    s_mov_b64 exec, -1
    v_mfma_f32_16x16x32_bf16 v[32:35], v[72:75], v[12:15], 0
    v_mfma_f32_16x16x32_bf16 v[32:35], v[76:79], v[16:19], v[32:35]
    v_lshlrev_b32 v36, 4, v0
    s_or_b32 s61, s60, s15
    s_cbranch_scc1 k_own_a
    buffer_store_dwordx4 v[120:123], v2, s[48:51], s13 offen sc1
k_own_a:
    s_nop 4
    ds_write_b128 v36, v[32:35] offset:34816
    s_waitcnt lgkmcnt(0)
    s_barrier
    s_cmp_lg_u32 s7, 0
    s_cbranch_scc1 k_end
    ds_read_b128 v[40:43], v36 offset:34816
    ds_read_b128 v[44:47], v36 offset:35840
    ds_read_b128 v[48:51], v36 offset:36864
    ds_read_b128 v[52:55], v36 offset:37888
    ds_read_b128 v[56:59], v36 offset:38912
    ds_read_b128 v[60:63], v36 offset:39936
    ds_read_b128 v[64:67], v36 offset:40960
    ds_read_b128 v[68:71], v36 offset:41984
    s_mov_b32 s64, 0xbfb8aa3b
    s_mul_i32 s65, s4, 28
    s_add_u32 s65, s65, s5
    s_lshl_b32 s65, s65, 7
    s_add_u32 s65, s65, 8454144
    v_and_b32 v81, 15, v1
    v_lshlrev_b32 v82, 4, v81
    v_lshl_add_u32 v80, v6, 3, v82
    s_waitcnt lgkmcnt(3)
    v_pk_add_f32 v[40:41], v[40:41], v[56:57]
    v_pk_add_f32 v[42:43], v[42:43], v[58:59]
    s_waitcnt lgkmcnt(2)
    v_pk_add_f32 v[44:45], v[44:45], v[60:61]
    v_pk_add_f32 v[46:47], v[46:47], v[62:63]
    s_waitcnt lgkmcnt(1)
    v_pk_add_f32 v[48:49], v[48:49], v[64:65]
    v_pk_add_f32 v[50:51], v[50:51], v[66:67]
    s_waitcnt lgkmcnt(0)
    v_pk_add_f32 v[52:53], v[52:53], v[68:69]
    v_pk_add_f32 v[54:55], v[54:55], v[70:71]
    v_pk_add_f32 v[40:41], v[40:41], v[48:49]
    v_pk_add_f32 v[42:43], v[42:43], v[50:51]
    v_pk_add_f32 v[44:45], v[44:45], v[52:53]
    v_pk_add_f32 v[46:47], v[46:47], v[54:55]
    v_pk_add_f32 v[40:41], v[40:41], v[44:45]
    v_pk_add_f32 v[42:43], v[42:43], v[46:47]
    v_cvt_pk_bf16_f32 v40, 0, v40
    v_cvt_pk_bf16_f32 v41, 0, v41
    v_cvt_pk_bf16_f32 v42, 0, v42
    v_cvt_pk_bf16_f32 v43, 0, v43
    v_mov_b32 v44, v40
    v_mov_b32 v45, v41
    v_mov_b32 v46, v42
    v_mov_b32 v47, v43
    v_mul_f32 v52, s64, v40
    v_mul_f32 v53, s64, v41
    v_mul_f32 v54, s64, v42
    v_mul_f32 v55, s64, v43
    v_exp_f32 v52, v52
    v_exp_f32 v53, v53
    v_exp_f32 v54, v54
    v_exp_f32 v55, v55
    v_add_f32 v52, 1.0, v52
    v_add_f32 v53, 1.0, v53
    v_add_f32 v54, 1.0, v54
    v_add_f32 v55, 1.0, v55
    v_rcp_f32 v52, v52
    v_rcp_f32 v53, v53
    v_rcp_f32 v54, v54
    v_rcp_f32 v55, v55
    v_mul_f32 v52, v52, v40
    v_mul_f32 v53, v53, v41
    v_mul_f32 v54, v54, v42
    v_mul_f32 v55, v55, v43
    v_cvt_pk_bf16_f32 v52, 0, v52
    v_cvt_pk_bf16_f32 v53, 0, v53
    v_cvt_pk_bf16_f32 v54, 0, v54
    v_cvt_pk_bf16_f32 v55, 0, v55
    v_permlane32_swap_b32 v44, v48
    v_permlane32_swap_b32 v45, v49
    v_permlane32_swap_b32 v46, v50
    v_permlane32_swap_b32 v47, v51
    v_mul_f32 v52, v52, v48
    v_mul_f32 v53, v53, v49
    v_mul_f32 v54, v54, v50
    v_mul_f32 v55, v55, v51
    v_cvt_pk_bf16_f32 v56, v52, v53
    v_cvt_pk_bf16_f32 v57, v54, v55
    v_min_u32 v56, -2, v56
    v_min_u32 v57, -2, v57
    s_mov_b32 exec_lo, 0x00ff00ff
    s_mov_b32 exec_hi, 0
    buffer_store_dwordx2 v[56:57], v80, s[56:59], s65 offen sc1
    s_branch k_end
k_ffn2:
    v_cmp_eq_u32 vcc, s14, v7
    s_nop 0
    s_and_b32 s60, vcc_lo, 0xff
    s_mov_b32 s48, s42
    s_mov_b32 s49, s43
    s_mov_b32 s50, 0x200000
    s_mov_b32 s51, 0x00020000
    s_andn2_b32 s63, s60, s62
    s_cmp_eq_u32 s63, 0
    s_cbranch_scc1 k_noselb
    s_ff1_i32_b32 s61, s60
    s_lshl_b32 s61, s61, 11
    s_add_u32 s61, s61, 8486912
    buffer_store_dwordx4 v[128:131], v2, s[56:59], s61 offen sc1
    buffer_store_dwordx4 v[124:127], v2, s[56:59], s61 offen offset:1024 sc1
k_noselb:
    s_or_b32 s61, s60, s15
    s_cbranch_scc1 k_own_b
    buffer_store_dwordx4 v[120:123], v2, s[48:51], s13 offen sc1
k_own_b:
    s_lshl_b32 s8, s4, 2
    s_add_u32 s8, s8, s5
    s_sub_u32 s8, s8, 28
    s_lshl_b32 s9, s8, 5
    s_mul_i32 s64, s7, 7168
    s_add_u32 s64, s64, 94720
    s_mov_b32 s52, s36
    s_mov_b32 s53, s37
    s_mov_b32 s54, 0x1c0000
    s_mov_b32 s55, 0x00020000
    v_lshrrev_b32 v15, 1, v1
    v_and_b32 v16, 0x13, v15
    v_bfe_u32 v17, v15, 2, 1
    v_lshl_or_b32 v16, v17, 3, v16
    v_bfe_u32 v17, v15, 3, 1
    v_lshl_or_b32 v16, v17, 2, v16
    v_lshlrev_b32 v15, 10, v16
    v_and_b32 v16, 1, v1
    v_lshl_add_u32 v15, v16, 4, v15
    s_mul_i32 s65, s7, 229376
    s_add_u32 s65, s65, s9
    s_add_u32 s65, s65, 163840
    s_add_u32 s10, s64, 5120
    s_mov_b32 m0, s10
    s_add_u32 s10, s10, 1024
    buffer_load_dwordx4 v15, s[52:55], s65 offen lds
    s_add_u32 s65, s65, 32768
    s_mov_b32 m0, s10
    s_add_u32 s10, s10, 1024
    buffer_load_dwordx4 v15, s[52:55], s65 offen lds
    s_add_u32 s65, s65, 32768
    v_and_b32 v20, 3, v1
    v_bfe_u32 v21, v1, 2, 2
    v_lshrrev_b32 v22, 1, v6
    v_lshlrev_b32 v22, 9, v22
    v_and_b32 v23, 1, v6
    v_lshl_add_u32 v22, v23, 7, v22
    v_lshl_add_u32 v22, v21, 5, v22
    v_lshl_add_u32 v22, v20, 3, v22
    v_add_u32 v22, s64, v22
    ds_read_b64_tr_b16 v[64:65], v22 offset:0
    ds_read_b64_tr_b16 v[66:67], v22 offset:256
    ds_read_b64_tr_b16 v[68:69], v22 offset:1024
    ds_read_b64_tr_b16 v[70:71], v22 offset:1280
    ds_read_b64_tr_b16 v[72:73], v22 offset:2048
    ds_read_b64_tr_b16 v[74:75], v22 offset:2304
    ds_read_b64_tr_b16 v[76:77], v22 offset:3072
    ds_read_b64_tr_b16 v[78:79], v22 offset:3328
    ds_read_b64_tr_b16 v[80:81], v22 offset:4096
    ds_read_b64_tr_b16 v[82:83], v22 offset:4352
    v_lshlrev_b32 v9, 7, v6
    v_lshl_add_u32 v9, v4, 4, v9
    s_mul_i32 s11, s7, 3584
    s_add_u32 s11, s11, 8454144
    v_lshl_add_u32 v8, v6, 3, v8
    s_cmp_lg_u32 s7, 0
    s_cbranch_scc1 k_f2_act
    v_lshl_add_u32 v10, v6, 3, v10
    s_add_u32 s61, s9, 6291456
    s_add_u32 s62, s9, 8486912
    v_lshlrev_b32 v11, 3, v6
    v_add_u32 v11, s9, v11
    ds_read_b64 v[16:17], v11 offset:23552
    v_and_b32 v30, s3, v7
    v_ashrrev_i32 v31, 31, v30
    v_not_b32 v31, v31
    v_or_b32 v31, 0x80000000, v31
    v_xor_b32 v30, v30, v31
    v_and_b32 v30, s3, v30
    s_mov_b32 s64, 0xbfb8aa3b
    v_mul_f32 v31, s64, v30
    v_exp_f32 v31, v31
    s_nop 0
    v_add_f32 v31, 1.0, v31
    v_rcp_f32 v31, v31
    s_nop 0
    v_cvt_pk_bf16_f32 v31, 0, v31
    s_waitcnt lgkmcnt(0)
    v_lshlrev_b32 v92, 16, v16
    v_and_b32 v93, s3, v16
    v_lshlrev_b32 v94, 16, v17
    v_and_b32 v95, s3, v17
    s_mov_b32 s64, 0
poll4:
    buffer_load_dwordx2 v[12:13], v10, s[56:59], s62 offen sc1
    buffer_load_dwordx2 v[14:15], v10, s[56:59], s62 offen offset:1024 sc1
    s_waitcnt vmcnt(0)
    v_max3_u32 v29, v12, v13, v14
    v_max_u32 v29, v29, v15
    v_cmp_eq_u32 vcc, -1, v29
    s_add_u32 s64, s64, 1
    s_and_b64 exec, exec, vcc
    s_cbranch_execz poll4_done
    s_cmp_lt_u32 s64, 16384
    s_cbranch_scc1 poll4
poll4_done:
    s_mov_b64 exec, -1
    v_lshlrev_b32 v96, 16, v12
    v_and_b32 v97, s3, v12
    v_lshlrev_b32 v98, 16, v13
    v_and_b32 v99, s3, v13
    v_lshlrev_b32 v100, 16, v14
    v_and_b32 v101, s3, v14
    v_lshlrev_b32 v102, 16, v15
    v_and_b32 v103, s3, v15
k_f2_act:
    s_waitcnt vmcnt(0) lgkmcnt(0)
    ds_read_b64_tr_b16 v[84:85], v22 offset:5120
    ds_read_b64_tr_b16 v[86:87], v22 offset:5376
    ds_read_b64_tr_b16 v[88:89], v22 offset:6144
    ds_read_b64_tr_b16 v[90:91], v22 offset:6400
    s_mov_b32 s64, 0
    s_mov_b32 exec_lo, 0xff00ff
    s_mov_b32 exec_hi, 0xff00ff
poll5:
    buffer_load_dwordx4 v[32:35], v9, s[56:59], s11 offen offset:0 sc1
    buffer_load_dwordx4 v[36:39], v9, s[56:59], s11 offen offset:512 sc1
    buffer_load_dwordx4 v[40:43], v9, s[56:59], s11 offen offset:1024 sc1
    buffer_load_dwordx4 v[44:47], v9, s[56:59], s11 offen offset:1536 sc1
    buffer_load_dwordx4 v[48:51], v9, s[56:59], s11 offen offset:2048 sc1
    buffer_load_dwordx4 v[52:55], v9, s[56:59], s11 offen offset:2560 sc1
    buffer_load_dwordx4 v[56:59], v9, s[56:59], s11 offen offset:3072 sc1
    s_waitcnt vmcnt(0)
    v_max3_u32 v29, v32, v33, v34
    v_max3_u32 v29, v29, v35, v36
    v_max3_u32 v29, v29, v37, v38
    v_max3_u32 v29, v29, v39, v40
    v_max3_u32 v29, v29, v41, v42
    v_max3_u32 v29, v29, v43, v44
    v_max3_u32 v29, v29, v45, v46
    v_max3_u32 v29, v29, v47, v48
    v_max3_u32 v29, v29, v49, v50
    v_max3_u32 v29, v29, v51, v52
    v_max3_u32 v29, v29, v53, v54
    v_max3_u32 v29, v29, v55, v56
    v_max3_u32 v29, v29, v57, v58
    v_max_u32 v29, v29, v59
    v_cmp_eq_u32 vcc, -1, v29
    s_add_u32 s64, s64, 1
    s_and_b64 exec, exec, vcc
    s_cbranch_execz poll5_done
    s_cmp_lt_u32 s64, 16384
    s_cbranch_scc1 poll5
poll5_done:
    s_mov_b64 exec, -1
    v_mfma_f32_16x16x32_bf16 v[24:27], v[64:67], v[32:35], 0
    v_mfma_f32_16x16x32_bf16 v[24:27], v[68:71], v[36:39], v[24:27]
    v_mfma_f32_16x16x32_bf16 v[24:27], v[72:75], v[40:43], v[24:27]
    v_mfma_f32_16x16x32_bf16 v[24:27], v[76:79], v[44:47], v[24:27]
    v_mfma_f32_16x16x32_bf16 v[24:27], v[80:83], v[48:51], v[24:27]
    s_waitcnt lgkmcnt(2)
    v_mfma_f32_16x16x32_bf16 v[24:27], v[84:87], v[52:55], v[24:27]
    s_waitcnt lgkmcnt(0)
    v_mfma_f32_16x16x32_bf16 v[24:27], v[88:91], v[56:59], v[24:27]
    v_lshlrev_b32 v28, 4, v0
    s_nop 6
    ds_write_b128 v28, v[24:27] offset:34816
    s_waitcnt lgkmcnt(0)
    s_barrier
    s_cmp_lg_u32 s7, 0
    s_cbranch_scc1 k_end
    ds_read_b128 v[40:43], v28 offset:34816
    ds_read_b128 v[44:47], v28 offset:35840
    ds_read_b128 v[48:51], v28 offset:36864
    ds_read_b128 v[52:55], v28 offset:37888
    ds_read_b128 v[56:59], v28 offset:38912
    ds_read_b128 v[60:63], v28 offset:39936
    ds_read_b128 v[64:67], v28 offset:40960
    ds_read_b128 v[68:71], v28 offset:41984
    s_waitcnt lgkmcnt(3)
    v_pk_add_f32 v[40:41], v[40:41], v[56:57]
    v_pk_add_f32 v[42:43], v[42:43], v[58:59]
    s_waitcnt lgkmcnt(2)
    v_pk_add_f32 v[44:45], v[44:45], v[60:61]
    v_pk_add_f32 v[46:47], v[46:47], v[62:63]
    s_waitcnt lgkmcnt(1)
    v_pk_add_f32 v[48:49], v[48:49], v[64:65]
    v_pk_add_f32 v[50:51], v[50:51], v[66:67]
    s_waitcnt lgkmcnt(0)
    v_pk_add_f32 v[52:53], v[52:53], v[68:69]
    v_pk_add_f32 v[54:55], v[54:55], v[70:71]
    v_pk_add_f32 v[40:41], v[40:41], v[48:49]
    v_pk_add_f32 v[42:43], v[42:43], v[50:51]
    v_pk_add_f32 v[44:45], v[44:45], v[52:53]
    v_pk_add_f32 v[46:47], v[46:47], v[54:55]
    v_pk_add_f32 v[40:41], v[40:41], v[44:45]
    v_pk_add_f32 v[42:43], v[42:43], v[46:47]
    v_cvt_pk_bf16_f32 v40, 0, v40
    v_cvt_pk_bf16_f32 v41, 0, v41
    v_cvt_pk_bf16_f32 v42, 0, v42
    v_cvt_pk_bf16_f32 v43, 0, v43
    v_mul_f32 v40, v40, v31
    v_mul_f32 v41, v41, v31
    v_mul_f32 v42, v42, v31
    v_mul_f32 v43, v43, v31
    v_cvt_pk_bf16_f32 v40, 0, v40
    v_cvt_pk_bf16_f32 v41, 0, v41
    v_cvt_pk_bf16_f32 v42, 0, v42
    v_cvt_pk_bf16_f32 v43, 0, v43
    v_pk_add_f32 v[40:41], v[40:41], v[96:97]
    v_pk_add_f32 v[42:43], v[42:43], v[98:99]
    v_cvt_pk_bf16_f32 v40, 0, v40
    v_cvt_pk_bf16_f32 v41, 0, v41
    v_cvt_pk_bf16_f32 v42, 0, v42
    v_cvt_pk_bf16_f32 v43, 0, v43
    v_pk_mul_f32 v[40:41], v[40:41], v[92:93]
    v_pk_mul_f32 v[42:43], v[42:43], v[94:95]
    v_cvt_pk_bf16_f32 v40, 0, v40
    v_cvt_pk_bf16_f32 v41, 0, v41
    v_cvt_pk_bf16_f32 v42, 0, v42
    v_cvt_pk_bf16_f32 v43, 0, v43
    v_pk_add_f32 v[40:41], v[40:41], v[100:101]
    v_pk_add_f32 v[42:43], v[42:43], v[102:103]
    v_cvt_pk_bf16_f32 v44, v40, v41
    v_cvt_pk_bf16_f32 v45, v42, v43
    s_mov_b32 exec_lo, 0x00ff00ff
    s_mov_b32 exec_hi, 0x00ff00ff
    buffer_store_dwordx2 v[44:45], v8, s[48:51], s9 offen sc1
k_end:
k_exit:
    s_endpgm
k_helper:
    v_add_u32 v3, s67, v2
    v_mov_b32 v11, 0
    v_cmp_eq_u32 vcc, 3, v1
    s_cmp_eq_u32 s9, 1
    s_cselect_b64 s[62:63], vcc, 0
    s_sub_u32 s68, s7, 4
    s_waitcnt vmcnt(0)
    v_cndmask_b32 v7, v7, v9, s[62:63]
    s_mov_b64 exec, 15
    ds_write_b128 v3, v[4:7]
    s_mov_b64 exec, -1
    s_sleep 12
    v_lshlrev_b32 v48, 4, v0
    s_lshl_b32 s8, s6, 14
    s_add_u32 s9, s8, 8192
    v_lshlrev_b32 v49, 3, v0
    v_add_u32 v49, 59392, v49
    s_mov_b32 s64, 0
uf1:
    buffer_load_dwordx4 v[40:43], v48, s[56:59], s8 offen sc1
    buffer_load_dwordx4 v[44:47], v48, s[56:59], s9 offen sc1
    s_waitcnt vmcnt(0)
    v_subrev_u32 v50, s28, v43
    v_subrev_u32 v51, s28, v47
    v_xor_b32 v52, s29, v42
    v_xor_b32 v53, s29, v46
    v_max_u32 v50, v50, v51
    v_or_b32 v52, v52, v53
    v_and_or_b32 v50, v52, s3, v50
    v_cmp_le_u32 vcc, 2048, v50
    s_add_u32 s64, s64, 1
    s_and_b64 exec, exec, vcc
    s_cbranch_execz uf1_done
    s_cmp_lt_u32 s64, 20
    s_cbranch_scc1 uf1
    s_branch uf1_more
uf1_done:
    s_mov_b64 exec, -1
    ds_write_b64 v49, v[40:41] offset:0
    v_alignbit_b32 v50, v41, v40, 16
    v_alignbit_b32 v51, v42, v41, 16
    ds_write_b64 v49, v[50:51] offset:4576
    ds_write_b64 v49, v[44:45] offset:17664
    v_alignbit_b32 v52, v45, v44, 16
    v_alignbit_b32 v53, v46, v45, 16
    ds_write_b64 v49, v[52:53] offset:22240
    s_waitcnt lgkmcnt(0)
    s_mov_b64 exec, 1
    ds_add_u32 v4, v8 offset:652
    s_mov_b64 exec, -1
    s_mov_b32 s48, s16
    s_mov_b32 s49, s17
    s_mov_b32 s50, 0x200000
    s_mov_b32 s51, 0x00020000
    s_mov_b32 s16, s32
    s_mov_b32 s17, s33
    s_mov_b32 s18, 0x1c0000
    s_mov_b32 s19, 0x00020000
    s_mov_b32 s20, s34
    s_mov_b32 s21, s35
    s_mov_b32 s22, 0x1c0000
    s_mov_b32 s23, 0x00020000
    s_mov_b32 s24, s36
    s_mov_b32 s25, s37
    s_mov_b32 s26, 0x1c0000
    s_mov_b32 s27, 0x00020000
    s_lshl_b32 s64, s7, 10
    s_add_u32 s64, s64, 10240
    s_mov_b32 m0, s64
    s_sub_u32 s64, s64, 4096
    s_sub_u32 s67, s13, 4096
    buffer_load_dwordx4 v2, s[48:51], s13 offen lds
    s_mov_b32 m0, s64
    s_nop 0
    buffer_load_dwordx4 v2, s[48:51], s67 offen lds
    s_cmp_ge_u32 s5, 28
    s_cbranch_scc1 k_h_wd
    s_mul_i32 s10, s4, 28
    s_add_u32 s10, s10, s5
    s_lshl_b32 s10, s10, 4
    s_mul_i32 s64, s68, 458752
    s_add_u32 s10, s10, s64
    v_mul_u32_u24 v15, 3584, v1
    s_lshl_b32 s9, s68, 11
    s_add_u32 s9, s9, 94720
    s_mov_b32 m0, s9
    s_add_u32 s11, s9, 8256
    buffer_load_dwordx4 v15, s[16:19], s10 offen lds
    s_mov_b32 m0, s11
    s_add_u32 s9, s9, 1024
    buffer_load_dwordx4 v15, s[20:23], s10 offen lds
    s_add_u32 s10, s10, 229376
    s_mov_b32 m0, s9
    s_add_u32 s11, s9, 8256
    buffer_load_dwordx4 v15, s[16:19], s10 offen lds
    s_mov_b32 m0, s11
    s_add_u32 s9, s9, 1024
    buffer_load_dwordx4 v15, s[20:23], s10 offen lds
    s_add_u32 s10, s10, 229376
    s_branch k_h_done
k_h_wd:
    s_lshl_b32 s8, s4, 2
    s_add_u32 s8, s8, s5
    s_sub_u32 s8, s8, 28
    s_lshl_b32 s8, s8, 5
    v_lshrrev_b32 v15, 1, v1
    v_and_b32 v16, 0x13, v15
    v_bfe_u32 v17, v15, 2, 1
    v_lshl_or_b32 v16, v17, 3, v16
    v_bfe_u32 v17, v15, 3, 1
    v_lshl_or_b32 v16, v17, 2, v16
    v_lshlrev_b32 v15, 10, v16
    v_and_b32 v16, 1, v1
    v_lshl_add_u32 v15, v16, 4, v15
    s_mul_i32 s64, s68, 458752
    s_add_u32 s8, s8, s64
    s_mul_i32 s9, s68, 14336
    s_add_u32 s9, s9, 94720
    s_mov_b32 m0, s9
    s_add_u32 s9, s9, 1024
    buffer_load_dwordx4 v15, s[24:27], s8 offen lds
    s_add_u32 s8, s8, 32768
    s_mov_b32 m0, s9
    s_add_u32 s9, s9, 1024
    buffer_load_dwordx4 v15, s[24:27], s8 offen lds
    s_add_u32 s8, s8, 32768
    s_mov_b32 m0, s9
    s_add_u32 s9, s9, 1024
    buffer_load_dwordx4 v15, s[24:27], s8 offen lds
    s_add_u32 s8, s8, 32768
    s_mov_b32 m0, s9
    s_add_u32 s9, s9, 1024
    buffer_load_dwordx4 v15, s[24:27], s8 offen lds
    s_add_u32 s8, s8, 32768
    s_mov_b32 m0, s9
    s_add_u32 s9, s9, 3072
    buffer_load_dwordx4 v15, s[24:27], s8 offen lds
    s_add_u32 s8, s8, 98304
    s_mov_b32 m0, s9
    s_add_u32 s9, s9, 1024
    buffer_load_dwordx4 v15, s[24:27], s8 offen lds
    s_add_u32 s8, s8, 32768
    s_mov_b32 m0, s9
    s_add_u32 s9, s9, 1024
    buffer_load_dwordx4 v15, s[24:27], s8 offen lds
    s_add_u32 s8, s8, 32768
    s_mov_b32 m0, s9
    s_add_u32 s9, s9, 1024
    buffer_load_dwordx4 v15, s[24:27], s8 offen lds
    s_add_u32 s8, s8, 32768
    s_mov_b32 m0, s9
    s_add_u32 s9, s9, 1024
    buffer_load_dwordx4 v15, s[24:27], s8 offen lds
    s_add_u32 s8, s8, 32768
    s_mov_b32 m0, s9
    s_add_u32 s9, s9, 3072
    buffer_load_dwordx4 v15, s[24:27], s8 offen lds
    s_add_u32 s8, s8, 98304
k_h_done:
    s_waitcnt vmcnt(0)
    s_mov_b64 exec, 1
    ds_add_u32 v4, v8 offset:680
    s_mov_b64 exec, -1
    s_mov_b32 s64, 0
lw3:
    ds_read_b64 v[12:13], v4 offset:664
    s_add_u32 s64, s64, 1
    s_waitcnt lgkmcnt(0)
    v_readfirstlane_b32 s15, v13
    v_readfirstlane_b32 s14, v12
    s_cmp_lg_u32 s15, 0
    s_cbranch_scc1 lw3_ok
    s_cmp_lt_u32 s64, 262144
    s_cbranch_scc1 lw3
lw3_ok:
    s_branch k_epi
k_aux:
    s_load_dwordx16 s[32:47], s[0:1], 64
    s_mov_b32 s3, 0xffff0000
    s_lshl_b32 s6, s4, 5
    s_add_u32 s6, s6, s5
    v_lshlrev_b32 v2, 4, v1
    s_lshl_b32 s12, s6, 3
    s_add_u32 s12, s12, s7
    s_lshl_b32 s13, s12, 10
    s_cmp_eq_u32 s7, 8
    s_cbranch_scc1 k_loader
    s_memrealtime s[8:9]
    v_mov_b32 v4, 0
    s_waitcnt lgkmcnt(0)
    s_mov_b32 s28, s44
    s_mov_b32 s29, s45
    s_mov_b32 s30, 0x100
    s_mov_b32 s31, 0x00020000
    s_mov_b64 exec, 1
    s_cmp_lg_u32 s2, 0
    s_cbranch_scc1 k_ep_nopub
    s_lshl_b32 s9, s9, 16
    s_or_b32 s9, s9, 0x80000000
    v_mov_b32 v8, s8
    v_mov_b32 v9, s9
    buffer_store_dwordx2 v[8:9], v4, s[28:31], 0 offen sc1
k_ep_nopub:
    s_mov_b64 exec, -1
    s_add_u32 s56, s46, 0xf000000
    s_addc_u32 s57, s47, 0
    s_mov_b32 s58, 0x900000
    s_mov_b32 s59, 0x00020000
    v_mov_b32 v8, -1
    v_mov_b32 v9, -1
    v_mov_b32 v10, -1
    v_mov_b32 v11, -1
    s_barrier
    s_lshl_b32 s8, s6, 13
    s_add_u32 s9, s8, 4194304
    s_add_u32 s10, s9, 4096
    buffer_store_dwordx4 v[8:11], v2, s[56:59], s9 offen offset:0 sc1
    buffer_store_dwordx4 v[8:11], v2, s[56:59], s9 offen offset:1024 sc1
    buffer_store_dwordx4 v[8:11], v2, s[56:59], s9 offen offset:2048 sc1
    buffer_store_dwordx4 v[8:11], v2, s[56:59], s9 offen offset:3072 sc1
    buffer_store_dwordx4 v[8:11], v2, s[56:59], s10 offen offset:0 sc1
    buffer_store_dwordx4 v[8:11], v2, s[56:59], s10 offen offset:1024 sc1
    buffer_store_dwordx4 v[8:11], v2, s[56:59], s10 offen offset:2048 sc1
    buffer_store_dwordx4 v[8:11], v2, s[56:59], s10 offen offset:3072 sc1
    s_lshl_b32 s8, s6, 7
    s_add_u32 s8, s8, 8421376
    s_lshl_b32 s9, s2, 7
    s_add_u32 s9, s9, 8454144
    s_mov_b64 exec, 0xff
    buffer_store_dwordx4 v[8:11], v2, s[56:59], s8 offen sc1
    buffer_store_dwordx4 v[8:11], v2, s[56:59], s9 offen sc1
    s_mov_b64 exec, -1
    s_lshl_b32 s8, s6, 11
    s_add_u32 s8, s8, 8519680
    buffer_store_dwordx4 v[8:11], v2, s[56:59], s8 offen sc1
    buffer_store_dwordx4 v[8:11], v2, s[56:59], s8 offen offset:1024 sc1
    s_cmp_ge_u32 s2, 16
    s_cbranch_scc1 k_ld_nox1
    s_lshl_b32 s8, s2, 10
    s_add_u32 s8, s8, 8486912
    buffer_store_dwordx4 v[8:11], v2, s[56:59], s8 offen sc1
k_ld_nox1:
    s_mov_b64 exec, 1
    s_mov_b32 s64, 0
k_ep:
    buffer_load_dwordx2 v[72:73], v4, s[28:31], 0 offen sc1
    s_waitcnt vmcnt(0)
    v_readfirstlane_b32 s15, v73
    v_readfirstlane_b32 s14, v72
    s_cmp_lg_u32 s15, 0
    s_cbranch_scc1 k_ep_done
    s_add_u32 s64, s64, 1
    s_cmp_lt_u32 s64, 16384
    s_cbranch_scc1 k_ep
k_ep_done:
    v_mov_b32 v70, s14
    v_mov_b32 v71, s15
    ds_write_b64 v4, v[70:71] offset:664
    s_waitcnt lgkmcnt(0)
    s_branch k_end
k_loader:
    v_mov_b32 v4, 0
    v_mov_b32 v5, 0
    v_mov_b32 v6, 0
    v_mov_b32 v7, 0
    v_mov_b32 v3, 0
    ds_write_b128 v3, v[4:7] offset:640
    ds_write_b128 v3, v[4:7] offset:656
    ds_write_b128 v3, v[4:7] offset:672
    v_and_b32 v14, 1, v1
    v_lshrrev_b32 v15, 1, v1
    v_and_b32 v16, 0x13, v15
    v_bfe_u32 v17, v15, 2, 1
    v_lshl_or_b32 v16, v17, 3, v16
    v_bfe_u32 v17, v15, 3, 1
    v_lshl_or_b32 v16, v17, 2, v16
    v_mul_u32_u24 v12, 6144, v16
    v_lshl_add_u32 v12, v14, 4, v12
    s_mul_i32 s68, s4, 24
    s_add_u32 s68, s68, s5
    s_waitcnt lgkmcnt(0)
    s_add_u32 s56, s46, 0xf000000
    s_addc_u32 s57, s47, 0
    s_mov_b32 s58, 0x900000
    s_mov_b32 s59, 0x00020000
    s_barrier
    s_mov_b32 s52, s40
    s_mov_b32 s53, s41
    s_mov_b32 s54, 0x300000
    s_mov_b32 s55, 0x00020000
    s_mov_b32 s48, s38
    s_mov_b32 s49, s39
    s_mov_b32 s50, 0x400
    s_mov_b32 s51, 0x00020000
    buffer_load_dwordx4 v[16:19], v2, s[48:51], 0 offen
    s_mov_b32 s48, s30
    s_mov_b32 s49, s31
    s_mov_b32 s50, 0x400
    s_mov_b32 s51, 0x00020000
    s_mov_b32 m0, 1024
    s_nop 0
    buffer_load_dwordx4 v2, s[48:51], 0 offen lds
    v_lshrrev_b32 v10, 2, v1
    s_lshl_b32 s8, s5, 4
    v_add_u32 v10, s8, v10
    v_mul_u32_u24 v10, 6144, v10
    v_and_b32 v11, 3, v1
    v_lshl_add_u32 v11, v11, 7, v10
    v_lshl_add_u32 v13, v14, 7, v10
    s_mul_i32 s8, s4, 768
    buffer_load_dword v128, v11, s[52:55], s8 offen
    s_mov_b32 exec_lo, 0x33333333
    s_mov_b32 exec_hi, 0x33333333
    buffer_load_dword v129, v13, s[52:55], s8 offen offset:512
    s_mov_b64 exec, -1
    s_waitcnt vmcnt(2)
    v_mov_b32 v8, 1
    s_mov_b64 exec, 1
    ds_add_u32 v3, v8 offset:680
    s_mov_b64 exec, -1
    s_cmp_ge_u32 s5, 3
    s_cbranch_scc1 k_ld_nocode
    s_getpc_b64 s[8:9]
k_pc:
    s_sub_u32 s8, s8, k_pc-adaLN_cond__ssm_conv_h3__moe_arch_mod__prompt_kernel
    s_subb_u32 s9, s9, 0
    v_lshlrev_b32 v10, 7, v1
    s_lshl_b32 s10, s5, 13
    v_add_u32 v10, s10, v10
    s_mov_b32 s10, k_code_end-adaLN_cond__ssm_conv_h3__moe_arch_mod__prompt_kernel
    v_cmp_gt_u32 vcc, s10, v10
    s_nop 0
    s_and_b64 exec, exec, vcc
    s_cbranch_execz k_ld_nocode2
    global_load_dword v130, v10, s[8:9]
k_ld_nocode2:
    s_mov_b64 exec, -1
k_ld_nocode:
    s_mov_b32 s48, s32
    s_mov_b32 s49, s33
    s_mov_b32 s50, 0x1c0000
    s_mov_b32 s51, 0x00020000
    s_mov_b32 s28, s34
    s_mov_b32 s29, s35
    s_mov_b32 s30, 0x1c0000
    s_mov_b32 s31, 0x00020000
    s_mov_b32 s60, s36
    s_mov_b32 s61, s37
    s_mov_b32 s62, 0x1c0000
    s_mov_b32 s63, 0x00020000
    v_lshrrev_b32 v10, 2, v1
    s_lshl_b32 s8, s5, 4
    v_add_u32 v10, s8, v10
    v_mul_u32_u24 v10, 3584, v10
    v_and_b32 v11, 3, v1
    v_lshl_add_u32 v10, v11, 7, v10
    s_mul_i32 s8, s4, 448
    s_and_b32 s8, s8, 0xffffff80
    s_mul_i32 s9, s5, 56
    v_add_u32 v11, s9, v1
    v_lshlrev_b32 v11, 10, v11
    s_lshl_b32 s9, s4, 7
    v_lshrrev_b32 v6, 4, v1
    v_lshl_add_u32 v8, v14, 2, v6
    v_lshlrev_b32 v8, 4, v8
    s_cmp_ge_u32 s5, 24
    s_cbranch_scc1 k_ld_nowm
    v_lshlrev_b32 v24, 16, v16
    v_and_b32 v25, s3, v16
    v_lshlrev_b32 v26, 16, v17
    v_and_b32 v27, s3, v17
    v_lshlrev_b32 v28, 16, v18
    v_and_b32 v29, s3, v18
    v_lshlrev_b32 v30, 16, v19
    v_and_b32 v31, s3, v19
    s_mov_b32 s64, 0xbfb8aa3b
    v_mul_f32 v32, s64, v24
    v_mul_f32 v33, s64, v25
    v_mul_f32 v34, s64, v26
    v_mul_f32 v35, s64, v27
    v_mul_f32 v36, s64, v28
    v_mul_f32 v37, s64, v29
    v_mul_f32 v38, s64, v30
    v_mul_f32 v39, s64, v31
    v_exp_f32 v32, v32
    v_exp_f32 v33, v33
    v_exp_f32 v34, v34
    v_exp_f32 v35, v35
    v_exp_f32 v36, v36
    v_exp_f32 v37, v37
    v_exp_f32 v38, v38
    v_exp_f32 v39, v39
    v_add_f32 v32, 1.0, v32
    v_add_f32 v33, 1.0, v33
    v_add_f32 v34, 1.0, v34
    v_add_f32 v35, 1.0, v35
    v_add_f32 v36, 1.0, v36
    v_add_f32 v37, 1.0, v37
    v_add_f32 v38, 1.0, v38
    v_add_f32 v39, 1.0, v39
    v_rcp_f32 v32, v32
    v_rcp_f32 v33, v33
    v_rcp_f32 v34, v34
    v_rcp_f32 v35, v35
    v_rcp_f32 v36, v36
    v_rcp_f32 v37, v37
    v_rcp_f32 v38, v38
    v_rcp_f32 v39, v39
    v_mul_f32 v32, v32, v24
    v_mul_f32 v33, v33, v25
    v_mul_f32 v34, v34, v26
    v_mul_f32 v35, v35, v27
    v_mul_f32 v36, v36, v28
    v_mul_f32 v37, v37, v29
    v_mul_f32 v38, v38, v30
    v_mul_f32 v39, v39, v31
    v_cvt_pk_bf16_f32 v32, 0, v32
    v_cvt_pk_bf16_f32 v33, 0, v33
    v_cvt_pk_bf16_f32 v34, 0, v34
    v_cvt_pk_bf16_f32 v35, 0, v35
    v_cvt_pk_bf16_f32 v36, 0, v36
    v_cvt_pk_bf16_f32 v37, 0, v37
    v_cvt_pk_bf16_f32 v38, 0, v38
    v_cvt_pk_bf16_f32 v39, 0, v39
    v_cvt_pk_bf16_f32 v16, v32, v33
    v_cvt_pk_bf16_f32 v17, v34, v35
    v_cvt_pk_bf16_f32 v18, v36, v37
    v_cvt_pk_bf16_f32 v19, v38, v39
    v_add_u32 v13, 128000, v2
    ds_write_b128 v13, v[16:19]
    v_lshlrev_b32 v13, 4, v6
    v_add_u32 v13, 128000, v13
    v_and_b32 v20, 3, v1
    v_bfe_u32 v21, v1, 2, 2
    v_lshrrev_b32 v22, 1, v6
    v_lshlrev_b32 v22, 9, v22
    v_and_b32 v23, 1, v6
    v_lshl_add_u32 v22, v23, 7, v22
    v_lshl_add_u32 v22, v21, 5, v22
    v_lshl_add_u32 v22, v20, 3, v22
    v_add_u32 v22, 111616, v22
    s_waitcnt lgkmcnt(0)
    ds_read_b128 v[32:35], v13 offset:0
    ds_read_b128 v[36:39], v13 offset:64
    ds_read_b128 v[40:43], v13 offset:128
    ds_read_b128 v[44:47], v13 offset:192
    ds_read_b128 v[48:51], v13 offset:256
    ds_read_b128 v[52:55], v13 offset:320
    ds_read_b128 v[56:59], v13 offset:384
    ds_read_b128 v[60:63], v13 offset:448
    ds_read_b128 v[64:67], v13 offset:512
    ds_read_b128 v[68:71], v13 offset:576
    ds_read_b128 v[72:75], v13 offset:640
    ds_read_b128 v[76:79], v13 offset:704
    ds_read_b128 v[80:83], v13 offset:768
    ds_read_b128 v[84:87], v13 offset:832
    ds_read_b128 v[88:91], v13 offset:896
    ds_read_b128 v[92:95], v13 offset:960
    s_mov_b32 s64, 0
lw4:
    ds_read_b32 v24, v3 offset:660
    s_add_u32 s64, s64, 1
    s_waitcnt lgkmcnt(0)
    v_readfirstlane_b32 s65, v24
    s_nop 0
    s_cmp_ge_u32 s65, 8
    s_cbranch_scc1 lw4_ok
    s_sleep 1
    s_cmp_lt_u32 s64, 262144
    s_cbranch_scc1 lw4
lw4_ok:
    s_lshl_b32 s10, s68, 5
    s_mov_b32 s11, 111616
    s_mov_b32 m0, s11
    s_add_u32 s11, s11, 1024
    buffer_load_dwordx4 v12, s[52:55], s10 offen lds
    s_add_u32 s10, s10, 196608
    s_mov_b32 m0, s11
    s_add_u32 s11, s11, 1024
    buffer_load_dwordx4 v12, s[52:55], s10 offen lds
    s_add_u32 s10, s10, 196608
    s_mov_b32 m0, s11
    s_add_u32 s11, s11, 1024
    buffer_load_dwordx4 v12, s[52:55], s10 offen lds
    s_add_u32 s10, s10, 196608
    s_mov_b32 m0, s11
    s_add_u32 s11, s11, 1024
    buffer_load_dwordx4 v12, s[52:55], s10 offen lds
    s_add_u32 s10, s10, 196608
    s_mov_b32 m0, s11
    s_add_u32 s11, s11, 1024
    buffer_load_dwordx4 v12, s[52:55], s10 offen lds
    s_add_u32 s10, s10, 196608
    s_mov_b32 m0, s11
    s_add_u32 s11, s11, 1024
    buffer_load_dwordx4 v12, s[52:55], s10 offen lds
    s_add_u32 s10, s10, 196608
    s_mov_b32 m0, s11
    s_add_u32 s11, s11, 1024
    buffer_load_dwordx4 v12, s[52:55], s10 offen lds
    s_add_u32 s10, s10, 196608
    s_mov_b32 m0, s11
    s_add_u32 s11, s11, 1024
    buffer_load_dwordx4 v12, s[52:55], s10 offen lds
    s_add_u32 s10, s10, 196608
    s_mov_b32 m0, s11
    s_add_u32 s11, s11, 1024
    buffer_load_dwordx4 v12, s[52:55], s10 offen lds
    s_add_u32 s10, s10, 196608
    s_mov_b32 m0, s11
    s_add_u32 s11, s11, 1024
    buffer_load_dwordx4 v12, s[52:55], s10 offen lds
    s_add_u32 s10, s10, 196608
    s_mov_b32 m0, s11
    s_add_u32 s11, s11, 1024
    buffer_load_dwordx4 v12, s[52:55], s10 offen lds
    s_add_u32 s10, s10, 196608
    s_mov_b32 m0, s11
    s_add_u32 s11, s11, 1024
    buffer_load_dwordx4 v12, s[52:55], s10 offen lds
    s_add_u32 s10, s10, 196608
    s_mov_b32 m0, s11
    s_add_u32 s11, s11, 1024
    buffer_load_dwordx4 v12, s[52:55], s10 offen lds
    s_add_u32 s10, s10, 196608
    s_mov_b32 m0, s11
    s_add_u32 s11, s11, 1024
    buffer_load_dwordx4 v12, s[52:55], s10 offen lds
    s_add_u32 s10, s10, 196608
    s_mov_b32 m0, s11
    s_add_u32 s11, s11, 1024
    buffer_load_dwordx4 v12, s[52:55], s10 offen lds
    s_add_u32 s10, s10, 196608
    s_mov_b32 m0, s11
    s_add_u32 s11, s11, 1024
    buffer_load_dwordx4 v12, s[52:55], s10 offen lds
    s_add_u32 s10, s10, 196608
    s_waitcnt vmcnt(0)
    ds_read_b64_tr_b16 v[96:97], v22 offset:0
    ds_read_b64_tr_b16 v[98:99], v22 offset:256
    ds_read_b64_tr_b16 v[100:101], v22 offset:1024
    ds_read_b64_tr_b16 v[102:103], v22 offset:1280
    ds_read_b64_tr_b16 v[104:105], v22 offset:2048
    ds_read_b64_tr_b16 v[106:107], v22 offset:2304
    ds_read_b64_tr_b16 v[108:109], v22 offset:3072
    ds_read_b64_tr_b16 v[110:111], v22 offset:3328
    ds_read_b64_tr_b16 v[112:113], v22 offset:4096
    ds_read_b64_tr_b16 v[114:115], v22 offset:4352
    ds_read_b64_tr_b16 v[116:117], v22 offset:5120
    ds_read_b64_tr_b16 v[118:119], v22 offset:5376
    ds_read_b64_tr_b16 v[120:121], v22 offset:6144
    ds_read_b64_tr_b16 v[122:123], v22 offset:6400
    ds_read_b64_tr_b16 v[124:125], v22 offset:7168
    ds_read_b64_tr_b16 v[126:127], v22 offset:7424
    ds_read_b64_tr_b16 v[128:129], v22 offset:8192
    ds_read_b64_tr_b16 v[130:131], v22 offset:8448
    ds_read_b64_tr_b16 v[132:133], v22 offset:9216
    ds_read_b64_tr_b16 v[134:135], v22 offset:9472
    ds_read_b64_tr_b16 v[136:137], v22 offset:10240
    ds_read_b64_tr_b16 v[138:139], v22 offset:10496
    ds_read_b64_tr_b16 v[140:141], v22 offset:11264
    ds_read_b64_tr_b16 v[142:143], v22 offset:11520
    ds_read_b64_tr_b16 v[144:145], v22 offset:12288
    ds_read_b64_tr_b16 v[146:147], v22 offset:12544
    ds_read_b64_tr_b16 v[148:149], v22 offset:13312
    ds_read_b64_tr_b16 v[150:151], v22 offset:13568
    ds_read_b64_tr_b16 v[152:153], v22 offset:14336
    ds_read_b64_tr_b16 v[154:155], v22 offset:14592
    ds_read_b64_tr_b16 v[156:157], v22 offset:15360
    ds_read_b64_tr_b16 v[158:159], v22 offset:15616
    s_setprio 3
    s_waitcnt lgkmcnt(15)
    v_mfma_f32_16x16x32_bf16 v[24:27], v[96:99], v[32:35], 0
    v_mfma_f32_16x16x32_bf16 v[28:31], v[100:103], v[36:39], 0
    v_mfma_f32_16x16x32_bf16 v[24:27], v[104:107], v[40:43], v[24:27]
    v_mfma_f32_16x16x32_bf16 v[28:31], v[108:111], v[44:47], v[28:31]
    v_mfma_f32_16x16x32_bf16 v[24:27], v[112:115], v[48:51], v[24:27]
    v_mfma_f32_16x16x32_bf16 v[28:31], v[116:119], v[52:55], v[28:31]
    v_mfma_f32_16x16x32_bf16 v[24:27], v[120:123], v[56:59], v[24:27]
    v_mfma_f32_16x16x32_bf16 v[28:31], v[124:127], v[60:63], v[28:31]
    s_waitcnt lgkmcnt(14)
    v_mfma_f32_16x16x32_bf16 v[24:27], v[128:131], v[64:67], v[24:27]
    s_waitcnt lgkmcnt(12)
    v_mfma_f32_16x16x32_bf16 v[28:31], v[132:135], v[68:71], v[28:31]
    s_waitcnt lgkmcnt(10)
    v_mfma_f32_16x16x32_bf16 v[24:27], v[136:139], v[72:75], v[24:27]
    s_waitcnt lgkmcnt(8)
    v_mfma_f32_16x16x32_bf16 v[28:31], v[140:143], v[76:79], v[28:31]
    s_waitcnt lgkmcnt(6)
    v_mfma_f32_16x16x32_bf16 v[24:27], v[144:147], v[80:83], v[24:27]
    s_waitcnt lgkmcnt(4)
    v_mfma_f32_16x16x32_bf16 v[28:31], v[148:151], v[84:87], v[28:31]
    s_waitcnt lgkmcnt(2)
    v_mfma_f32_16x16x32_bf16 v[24:27], v[152:155], v[88:91], v[24:27]
    s_waitcnt lgkmcnt(0)
    v_mfma_f32_16x16x32_bf16 v[28:31], v[156:159], v[92:95], v[28:31]
    s_lshr_b32 s64, s68, 5
    s_cmp_eq_u32 s64, 1
    s_cselect_b32 s66, 1.0, 0
    s_cmp_eq_u32 s64, 4
    s_cselect_b32 s66, 1.0, s66
    s_nop 2
    v_add_f32 v24, v24, v28
    v_add_f32 v25, v25, v29
    v_add_f32 v26, v26, v30
    v_add_f32 v27, v27, v31
    v_cvt_pk_bf16_f32 v24, 0, v24
    v_cvt_pk_bf16_f32 v25, 0, v25
    v_cvt_pk_bf16_f32 v26, 0, v26
    v_cvt_pk_bf16_f32 v27, 0, v27
    v_add_f32 v24, s66, v24
    v_add_f32 v25, s66, v25
    v_add_f32 v26, s66, v26
    v_add_f32 v27, s66, v27
    v_cvt_pk_bf16_f32 v40, v24, v25
    v_cvt_pk_bf16_f32 v41, v26, v27
k_ld_nowm:
    s_lshl_b32 s66, s6, 7
    s_add_u32 s66, s66, 8388608
    s_mov_b32 s64, 0
lw5:
    ds_read_b64 v[44:45], v3 offset:664
    s_add_u32 s64, s64, 1
    s_waitcnt lgkmcnt(0)
    v_readfirstlane_b32 s15, v45
    v_readfirstlane_b32 s14, v44
    s_cmp_lg_u32 s15, 0
    s_cbranch_scc1 lw5_ok
    s_cmp_lt_u32 s64, 262144
    s_cbranch_scc1 lw5
lw5_ok:
    v_mov_b32 v42, s14
    v_mov_b32 v43, s15
    s_mov_b32 exec_lo, 0x00030003
    s_mov_b32 exec_hi, 0x00030003
    buffer_store_dwordx4 v[40:43], v8, s[56:59], s66 offen sc1
    s_mov_b64 exec, -1
    s_mov_b32 s64, 0
lw6:
    ds_read_b32 v24, v3 offset:656
    s_add_u32 s64, s64, 1
    s_waitcnt lgkmcnt(0)
    v_readfirstlane_b32 s65, v24
    s_nop 0
    s_cmp_ge_u32 s65, 4
    s_cbranch_scc1 lw6_ok
    s_sleep 1
    s_cmp_lt_u32 s64, 262144
    s_cbranch_scc1 lw6
lw6_ok:
    buffer_load_dword v164, v10, s[48:51], s8 offen
    buffer_load_dword v165, v10, s[28:31], s8 offen
    s_mov_b32 exec_hi, 0x00ffffff
    buffer_load_dword v166, v11, s[60:63], s9 offen
    s_mov_b64 exec, -1
    s_branch k_end
uf0_more:
    s_mov_b64 exec, -1
    s_mov_b32 s48, s18
    s_mov_b32 s49, s19
    s_mov_b32 s50, 0x200000
    s_mov_b32 s51, 0x00020000
    s_mov_b32 s52, s20
    s_mov_b32 s53, s21
    s_mov_b32 s54, 0x200000
    s_mov_b32 s55, 0x00020000
    v_lshlrev_b32 v56, 12, v0
    v_sub_u32 v56, 2093056, v56
    s_lshl_b32 s64, s6, 2
    v_add_u32 v56, s64, v56
    v_subrev_u32 v57, 4096, v56
    v_mov_b32 v58, 0x80000000
    v_cmp_eq_u32 vcc, 511, v0
    s_nop 1
    v_cndmask_b32 v57, v57, v58, vcc
    s_lshl_b32 s64, s6, 4
    v_mov_b32 v58, s64
    buffer_load_dword v104, v57, s[48:51], 0 offen offset:0
    buffer_load_dword v105, v57, s[48:51], 0 offen offset:1024
    buffer_load_dword v106, v57, s[48:51], 0 offen offset:2048
    buffer_load_dword v107, v57, s[48:51], 0 offen offset:3072
    buffer_load_dword v108, v56, s[48:51], 0 offen offset:0
    buffer_load_dword v109, v56, s[48:51], 0 offen offset:1024
    buffer_load_dword v110, v56, s[48:51], 0 offen offset:2048
    buffer_load_dword v111, v56, s[48:51], 0 offen offset:3072
    buffer_load_dword v112, v57, s[52:55], 0 offen offset:3072
    buffer_load_dword v113, v56, s[52:55], 0 offen offset:0
    buffer_load_dword v114, v56, s[52:55], 0 offen offset:1024
    buffer_load_dword v115, v56, s[52:55], 0 offen offset:2048
    buffer_load_dword v116, v56, s[52:55], 0 offen offset:3072
    global_load_dwordx4 v[120:123], v58, s[22:23]
    s_waitcnt vmcnt(0)
    v_lshlrev_b32 v124, 16, v120
    v_and_b32 v126, s3, v120
    v_lshlrev_b32 v128, 16, v121
    v_and_b32 v130, s3, v121
    v_lshlrev_b32 v125, 16, v122
    v_and_b32 v127, s3, v122
    v_lshlrev_b32 v129, 16, v123
    v_and_b32 v131, s3, v123
    v_lshlrev_b32 v60, 16, v104
    v_and_b32 v61, s3, v104
    v_lshlrev_b32 v62, 16, v105
    v_and_b32 v63, s3, v105
    v_lshlrev_b32 v64, 16, v106
    v_and_b32 v65, s3, v106
    v_lshlrev_b32 v66, 16, v107
    v_and_b32 v67, s3, v107
    v_lshlrev_b32 v68, 16, v108
    v_and_b32 v69, s3, v108
    v_lshlrev_b32 v70, 16, v109
    v_and_b32 v71, s3, v109
    v_lshlrev_b32 v72, 16, v110
    v_and_b32 v73, s3, v110
    v_lshlrev_b32 v74, 16, v111
    v_and_b32 v75, s3, v111
    v_pk_mul_f32 v[80:81], v[60:61], v[130:131]
    v_pk_mul_f32 v[82:83], v[62:63], v[130:131]
    v_pk_mul_f32 v[84:85], v[64:65], v[130:131]
    v_pk_mul_f32 v[86:87], v[66:67], v[130:131]
    v_pk_mul_f32 v[88:89], v[68:69], v[130:131]
    v_cvt_pk_bf16_f32 v80, 0, v80
    v_cvt_pk_bf16_f32 v81, 0, v81
    v_cvt_pk_bf16_f32 v82, 0, v82
    v_cvt_pk_bf16_f32 v83, 0, v83
    v_cvt_pk_bf16_f32 v84, 0, v84
    v_cvt_pk_bf16_f32 v85, 0, v85
    v_cvt_pk_bf16_f32 v86, 0, v86
    v_cvt_pk_bf16_f32 v87, 0, v87
    v_cvt_pk_bf16_f32 v88, 0, v88
    v_cvt_pk_bf16_f32 v89, 0, v89
    v_pk_mul_f32 v[92:93], v[62:63], v[128:129]
    v_pk_mul_f32 v[94:95], v[64:65], v[128:129]
    v_pk_mul_f32 v[96:97], v[66:67], v[128:129]
    v_pk_mul_f32 v[98:99], v[68:69], v[128:129]
    v_pk_mul_f32 v[100:101], v[70:71], v[128:129]
    v_cvt_pk_bf16_f32 v92, 0, v92
    v_cvt_pk_bf16_f32 v93, 0, v93
    v_cvt_pk_bf16_f32 v94, 0, v94
    v_cvt_pk_bf16_f32 v95, 0, v95
    v_cvt_pk_bf16_f32 v96, 0, v96
    v_cvt_pk_bf16_f32 v97, 0, v97
    v_cvt_pk_bf16_f32 v98, 0, v98
    v_cvt_pk_bf16_f32 v99, 0, v99
    v_cvt_pk_bf16_f32 v100, 0, v100
    v_cvt_pk_bf16_f32 v101, 0, v101
    v_pk_add_f32 v[80:81], v[80:81], v[92:93]
    v_pk_add_f32 v[82:83], v[82:83], v[94:95]
    v_pk_add_f32 v[84:85], v[84:85], v[96:97]
    v_pk_add_f32 v[86:87], v[86:87], v[98:99]
    v_pk_add_f32 v[88:89], v[88:89], v[100:101]
    v_cvt_pk_bf16_f32 v80, 0, v80
    v_cvt_pk_bf16_f32 v81, 0, v81
    v_cvt_pk_bf16_f32 v82, 0, v82
    v_cvt_pk_bf16_f32 v83, 0, v83
    v_cvt_pk_bf16_f32 v84, 0, v84
    v_cvt_pk_bf16_f32 v85, 0, v85
    v_cvt_pk_bf16_f32 v86, 0, v86
    v_cvt_pk_bf16_f32 v87, 0, v87
    v_cvt_pk_bf16_f32 v88, 0, v88
    v_cvt_pk_bf16_f32 v89, 0, v89
    v_pk_mul_f32 v[92:93], v[64:65], v[126:127]
    v_pk_mul_f32 v[94:95], v[66:67], v[126:127]
    v_pk_mul_f32 v[96:97], v[68:69], v[126:127]
    v_pk_mul_f32 v[98:99], v[70:71], v[126:127]
    v_pk_mul_f32 v[100:101], v[72:73], v[126:127]
    v_cvt_pk_bf16_f32 v92, 0, v92
    v_cvt_pk_bf16_f32 v93, 0, v93
    v_cvt_pk_bf16_f32 v94, 0, v94
    v_cvt_pk_bf16_f32 v95, 0, v95
    v_cvt_pk_bf16_f32 v96, 0, v96
    v_cvt_pk_bf16_f32 v97, 0, v97
    v_cvt_pk_bf16_f32 v98, 0, v98
    v_cvt_pk_bf16_f32 v99, 0, v99
    v_cvt_pk_bf16_f32 v100, 0, v100
    v_cvt_pk_bf16_f32 v101, 0, v101
    v_pk_add_f32 v[80:81], v[80:81], v[92:93]
    v_pk_add_f32 v[82:83], v[82:83], v[94:95]
    v_pk_add_f32 v[84:85], v[84:85], v[96:97]
    v_pk_add_f32 v[86:87], v[86:87], v[98:99]
    v_pk_add_f32 v[88:89], v[88:89], v[100:101]
    v_cvt_pk_bf16_f32 v80, 0, v80
    v_cvt_pk_bf16_f32 v81, 0, v81
    v_cvt_pk_bf16_f32 v82, 0, v82
    v_cvt_pk_bf16_f32 v83, 0, v83
    v_cvt_pk_bf16_f32 v84, 0, v84
    v_cvt_pk_bf16_f32 v85, 0, v85
    v_cvt_pk_bf16_f32 v86, 0, v86
    v_cvt_pk_bf16_f32 v87, 0, v87
    v_cvt_pk_bf16_f32 v88, 0, v88
    v_cvt_pk_bf16_f32 v89, 0, v89
    v_pk_mul_f32 v[92:93], v[66:67], v[124:125]
    v_pk_mul_f32 v[94:95], v[68:69], v[124:125]
    v_pk_mul_f32 v[96:97], v[70:71], v[124:125]
    v_pk_mul_f32 v[98:99], v[72:73], v[124:125]
    v_pk_mul_f32 v[100:101], v[74:75], v[124:125]
    v_cvt_pk_bf16_f32 v92, 0, v92
    v_cvt_pk_bf16_f32 v93, 0, v93
    v_cvt_pk_bf16_f32 v94, 0, v94
    v_cvt_pk_bf16_f32 v95, 0, v95
    v_cvt_pk_bf16_f32 v96, 0, v96
    v_cvt_pk_bf16_f32 v97, 0, v97
    v_cvt_pk_bf16_f32 v98, 0, v98
    v_cvt_pk_bf16_f32 v99, 0, v99
    v_cvt_pk_bf16_f32 v100, 0, v100
    v_cvt_pk_bf16_f32 v101, 0, v101
    v_pk_add_f32 v[80:81], v[80:81], v[92:93]
    v_pk_add_f32 v[82:83], v[82:83], v[94:95]
    v_pk_add_f32 v[84:85], v[84:85], v[96:97]
    v_pk_add_f32 v[86:87], v[86:87], v[98:99]
    v_pk_add_f32 v[88:89], v[88:89], v[100:101]
    v_cvt_pk_bf16_f32 v80, 0, v80
    v_cvt_pk_bf16_f32 v81, 0, v81
    v_cvt_pk_bf16_f32 v82, 0, v82
    v_cvt_pk_bf16_f32 v83, 0, v83
    v_cvt_pk_bf16_f32 v84, 0, v84
    v_cvt_pk_bf16_f32 v85, 0, v85
    v_cvt_pk_bf16_f32 v86, 0, v86
    v_cvt_pk_bf16_f32 v87, 0, v87
    v_cvt_pk_bf16_f32 v88, 0, v88
    v_cvt_pk_bf16_f32 v89, 0, v89
    v_lshlrev_b32 v92, 16, v112
    v_and_b32 v93, s3, v112
    v_lshlrev_b32 v94, 16, v113
    v_and_b32 v95, s3, v113
    v_lshlrev_b32 v96, 16, v114
    v_and_b32 v97, s3, v114
    v_lshlrev_b32 v98, 16, v115
    v_and_b32 v99, s3, v115
    v_lshlrev_b32 v100, 16, v116
    v_and_b32 v101, s3, v116
    v_pk_mul_f32 v[80:81], v[80:81], v[92:93]
    v_pk_mul_f32 v[82:83], v[82:83], v[94:95]
    v_pk_mul_f32 v[84:85], v[84:85], v[96:97]
    v_pk_mul_f32 v[86:87], v[86:87], v[98:99]
    v_pk_mul_f32 v[88:89], v[88:89], v[100:101]
    v_cvt_pk_bf16_f32 v40, v88, v86
    v_cvt_pk_bf16_f32 v41, v84, v82
    v_cvt_pk_bf16_f32 v42, v80, 0
    v_cvt_pk_bf16_f32 v44, v89, v87
    v_cvt_pk_bf16_f32 v45, v85, v83
    v_cvt_pk_bf16_f32 v46, v81, 0
    s_nop 1
    s_branch uf0_done
uf1_more:
    s_mov_b64 exec, -1
    s_mov_b32 s48, s18
    s_mov_b32 s49, s19
    s_mov_b32 s50, 0x200000
    s_mov_b32 s51, 0x00020000
    s_mov_b32 s52, s20
    s_mov_b32 s53, s21
    s_mov_b32 s54, 0x200000
    s_mov_b32 s55, 0x00020000
    v_lshlrev_b32 v56, 12, v0
    v_sub_u32 v56, 2093056, v56
    s_lshl_b32 s64, s6, 2
    v_add_u32 v56, s64, v56
    v_subrev_u32 v57, 4096, v56
    v_mov_b32 v58, 0x80000000
    v_cmp_eq_u32 vcc, 511, v0
    s_nop 1
    v_cndmask_b32 v57, v57, v58, vcc
    s_lshl_b32 s64, s6, 4
    v_mov_b32 v58, s64
    buffer_load_dword v104, v57, s[48:51], 0 offen offset:0
    buffer_load_dword v105, v57, s[48:51], 0 offen offset:1024
    buffer_load_dword v106, v57, s[48:51], 0 offen offset:2048
    buffer_load_dword v107, v57, s[48:51], 0 offen offset:3072
    buffer_load_dword v108, v56, s[48:51], 0 offen offset:0
    buffer_load_dword v109, v56, s[48:51], 0 offen offset:1024
    buffer_load_dword v110, v56, s[48:51], 0 offen offset:2048
    buffer_load_dword v111, v56, s[48:51], 0 offen offset:3072
    buffer_load_dword v112, v57, s[52:55], 0 offen offset:3072
    buffer_load_dword v113, v56, s[52:55], 0 offen offset:0
    buffer_load_dword v114, v56, s[52:55], 0 offen offset:1024
    buffer_load_dword v115, v56, s[52:55], 0 offen offset:2048
    buffer_load_dword v116, v56, s[52:55], 0 offen offset:3072
    global_load_dwordx4 v[120:123], v58, s[22:23]
    s_waitcnt vmcnt(0)
    v_lshlrev_b32 v124, 16, v120
    v_and_b32 v126, s3, v120
    v_lshlrev_b32 v128, 16, v121
    v_and_b32 v130, s3, v121
    v_lshlrev_b32 v125, 16, v122
    v_and_b32 v127, s3, v122
    v_lshlrev_b32 v129, 16, v123
    v_and_b32 v131, s3, v123
    v_lshlrev_b32 v60, 16, v104
    v_and_b32 v61, s3, v104
    v_lshlrev_b32 v62, 16, v105
    v_and_b32 v63, s3, v105
    v_lshlrev_b32 v64, 16, v106
    v_and_b32 v65, s3, v106
    v_lshlrev_b32 v66, 16, v107
    v_and_b32 v67, s3, v107
    v_lshlrev_b32 v68, 16, v108
    v_and_b32 v69, s3, v108
    v_lshlrev_b32 v70, 16, v109
    v_and_b32 v71, s3, v109
    v_lshlrev_b32 v72, 16, v110
    v_and_b32 v73, s3, v110
    v_lshlrev_b32 v74, 16, v111
    v_and_b32 v75, s3, v111
    v_pk_mul_f32 v[80:81], v[60:61], v[130:131]
    v_pk_mul_f32 v[82:83], v[62:63], v[130:131]
    v_pk_mul_f32 v[84:85], v[64:65], v[130:131]
    v_pk_mul_f32 v[86:87], v[66:67], v[130:131]
    v_pk_mul_f32 v[88:89], v[68:69], v[130:131]
    v_cvt_pk_bf16_f32 v80, 0, v80
    v_cvt_pk_bf16_f32 v81, 0, v81
    v_cvt_pk_bf16_f32 v82, 0, v82
    v_cvt_pk_bf16_f32 v83, 0, v83
    v_cvt_pk_bf16_f32 v84, 0, v84
    v_cvt_pk_bf16_f32 v85, 0, v85
    v_cvt_pk_bf16_f32 v86, 0, v86
    v_cvt_pk_bf16_f32 v87, 0, v87
    v_cvt_pk_bf16_f32 v88, 0, v88
    v_cvt_pk_bf16_f32 v89, 0, v89
    v_pk_mul_f32 v[92:93], v[62:63], v[128:129]
    v_pk_mul_f32 v[94:95], v[64:65], v[128:129]
    v_pk_mul_f32 v[96:97], v[66:67], v[128:129]
    v_pk_mul_f32 v[98:99], v[68:69], v[128:129]
    v_pk_mul_f32 v[100:101], v[70:71], v[128:129]
    v_cvt_pk_bf16_f32 v92, 0, v92
    v_cvt_pk_bf16_f32 v93, 0, v93
    v_cvt_pk_bf16_f32 v94, 0, v94
    v_cvt_pk_bf16_f32 v95, 0, v95
    v_cvt_pk_bf16_f32 v96, 0, v96
    v_cvt_pk_bf16_f32 v97, 0, v97
    v_cvt_pk_bf16_f32 v98, 0, v98
    v_cvt_pk_bf16_f32 v99, 0, v99
    v_cvt_pk_bf16_f32 v100, 0, v100
    v_cvt_pk_bf16_f32 v101, 0, v101
    v_pk_add_f32 v[80:81], v[80:81], v[92:93]
    v_pk_add_f32 v[82:83], v[82:83], v[94:95]
    v_pk_add_f32 v[84:85], v[84:85], v[96:97]
    v_pk_add_f32 v[86:87], v[86:87], v[98:99]
    v_pk_add_f32 v[88:89], v[88:89], v[100:101]
    v_cvt_pk_bf16_f32 v80, 0, v80
    v_cvt_pk_bf16_f32 v81, 0, v81
    v_cvt_pk_bf16_f32 v82, 0, v82
    v_cvt_pk_bf16_f32 v83, 0, v83
    v_cvt_pk_bf16_f32 v84, 0, v84
    v_cvt_pk_bf16_f32 v85, 0, v85
    v_cvt_pk_bf16_f32 v86, 0, v86
    v_cvt_pk_bf16_f32 v87, 0, v87
    v_cvt_pk_bf16_f32 v88, 0, v88
    v_cvt_pk_bf16_f32 v89, 0, v89
    v_pk_mul_f32 v[92:93], v[64:65], v[126:127]
    v_pk_mul_f32 v[94:95], v[66:67], v[126:127]
    v_pk_mul_f32 v[96:97], v[68:69], v[126:127]
    v_pk_mul_f32 v[98:99], v[70:71], v[126:127]
    v_pk_mul_f32 v[100:101], v[72:73], v[126:127]
    v_cvt_pk_bf16_f32 v92, 0, v92
    v_cvt_pk_bf16_f32 v93, 0, v93
    v_cvt_pk_bf16_f32 v94, 0, v94
    v_cvt_pk_bf16_f32 v95, 0, v95
    v_cvt_pk_bf16_f32 v96, 0, v96
    v_cvt_pk_bf16_f32 v97, 0, v97
    v_cvt_pk_bf16_f32 v98, 0, v98
    v_cvt_pk_bf16_f32 v99, 0, v99
    v_cvt_pk_bf16_f32 v100, 0, v100
    v_cvt_pk_bf16_f32 v101, 0, v101
    v_pk_add_f32 v[80:81], v[80:81], v[92:93]
    v_pk_add_f32 v[82:83], v[82:83], v[94:95]
    v_pk_add_f32 v[84:85], v[84:85], v[96:97]
    v_pk_add_f32 v[86:87], v[86:87], v[98:99]
    v_pk_add_f32 v[88:89], v[88:89], v[100:101]
    v_cvt_pk_bf16_f32 v80, 0, v80
    v_cvt_pk_bf16_f32 v81, 0, v81
    v_cvt_pk_bf16_f32 v82, 0, v82
    v_cvt_pk_bf16_f32 v83, 0, v83
    v_cvt_pk_bf16_f32 v84, 0, v84
    v_cvt_pk_bf16_f32 v85, 0, v85
    v_cvt_pk_bf16_f32 v86, 0, v86
    v_cvt_pk_bf16_f32 v87, 0, v87
    v_cvt_pk_bf16_f32 v88, 0, v88
    v_cvt_pk_bf16_f32 v89, 0, v89
    v_pk_mul_f32 v[92:93], v[66:67], v[124:125]
    v_pk_mul_f32 v[94:95], v[68:69], v[124:125]
    v_pk_mul_f32 v[96:97], v[70:71], v[124:125]
    v_pk_mul_f32 v[98:99], v[72:73], v[124:125]
    v_pk_mul_f32 v[100:101], v[74:75], v[124:125]
    v_cvt_pk_bf16_f32 v92, 0, v92
    v_cvt_pk_bf16_f32 v93, 0, v93
    v_cvt_pk_bf16_f32 v94, 0, v94
    v_cvt_pk_bf16_f32 v95, 0, v95
    v_cvt_pk_bf16_f32 v96, 0, v96
    v_cvt_pk_bf16_f32 v97, 0, v97
    v_cvt_pk_bf16_f32 v98, 0, v98
    v_cvt_pk_bf16_f32 v99, 0, v99
    v_cvt_pk_bf16_f32 v100, 0, v100
    v_cvt_pk_bf16_f32 v101, 0, v101
    v_pk_add_f32 v[80:81], v[80:81], v[92:93]
    v_pk_add_f32 v[82:83], v[82:83], v[94:95]
    v_pk_add_f32 v[84:85], v[84:85], v[96:97]
    v_pk_add_f32 v[86:87], v[86:87], v[98:99]
    v_pk_add_f32 v[88:89], v[88:89], v[100:101]
    v_cvt_pk_bf16_f32 v80, 0, v80
    v_cvt_pk_bf16_f32 v81, 0, v81
    v_cvt_pk_bf16_f32 v82, 0, v82
    v_cvt_pk_bf16_f32 v83, 0, v83
    v_cvt_pk_bf16_f32 v84, 0, v84
    v_cvt_pk_bf16_f32 v85, 0, v85
    v_cvt_pk_bf16_f32 v86, 0, v86
    v_cvt_pk_bf16_f32 v87, 0, v87
    v_cvt_pk_bf16_f32 v88, 0, v88
    v_cvt_pk_bf16_f32 v89, 0, v89
    v_lshlrev_b32 v92, 16, v112
    v_and_b32 v93, s3, v112
    v_lshlrev_b32 v94, 16, v113
    v_and_b32 v95, s3, v113
    v_lshlrev_b32 v96, 16, v114
    v_and_b32 v97, s3, v114
    v_lshlrev_b32 v98, 16, v115
    v_and_b32 v99, s3, v115
    v_lshlrev_b32 v100, 16, v116
    v_and_b32 v101, s3, v116
    v_pk_mul_f32 v[80:81], v[80:81], v[92:93]
    v_pk_mul_f32 v[82:83], v[82:83], v[94:95]
    v_pk_mul_f32 v[84:85], v[84:85], v[96:97]
    v_pk_mul_f32 v[86:87], v[86:87], v[98:99]
    v_pk_mul_f32 v[88:89], v[88:89], v[100:101]
    v_cvt_pk_bf16_f32 v40, v88, v86
    v_cvt_pk_bf16_f32 v41, v84, v82
    v_cvt_pk_bf16_f32 v42, v80, 0
    v_cvt_pk_bf16_f32 v44, v89, v87
    v_cvt_pk_bf16_f32 v45, v85, v83
    v_cvt_pk_bf16_f32 v46, v81, 0
    s_nop 1
    s_branch uf1_done
k_tk_med:
    s_cmp_gt_u32 s64, 1
    s_cbranch_scc1 k_tk_slow
    s_waitcnt lgkmcnt(0)
    ds_read_b32 v44, v21 offset:2048
    ds_read_b32 v45, v21 offset:2304
    ds_read_b128 v[48:51], v31 offset:2080
    ds_read_b128 v[52:55], v31 offset:2096
    v_mov_b32 v46, 0
    v_mov_b32 v47, 0
    s_waitcnt lgkmcnt(3)
    v_cmp_gt_u32 s[48:49], v34, v44
    s_waitcnt lgkmcnt(2)
    v_cmp_gt_u32 s[50:51], v34, v45
    v_addc_co_u32 v46, vcc, 0, v46, s[48:49]
    s_nop 0
    v_addc_co_u32 v47, vcc, 0, v47, s[50:51]
    v_cmp_gt_u32 s[48:49], v35, v44
    v_cmp_gt_u32 s[50:51], v35, v45
    s_nop 0
    v_addc_co_u32 v46, vcc, 0, v46, s[48:49]
    v_addc_co_u32 v47, vcc, 0, v47, s[50:51]
    v_cmp_gt_u32 s[48:49], v36, v44
    v_cmp_gt_u32 s[50:51], v36, v45
    s_nop 0
    v_addc_co_u32 v46, vcc, 0, v46, s[48:49]
    v_addc_co_u32 v47, vcc, 0, v47, s[50:51]
    v_cmp_gt_u32 s[48:49], v37, v44
    v_cmp_gt_u32 s[50:51], v37, v45
    s_nop 0
    v_addc_co_u32 v46, vcc, 0, v46, s[48:49]
    v_addc_co_u32 v47, vcc, 0, v47, s[50:51]
    v_cmp_gt_u32 s[48:49], v38, v44
    v_cmp_gt_u32 s[50:51], v38, v45
    s_nop 0
    v_addc_co_u32 v46, vcc, 0, v46, s[48:49]
    v_addc_co_u32 v47, vcc, 0, v47, s[50:51]
    v_cmp_gt_u32 s[48:49], v39, v44
    v_cmp_gt_u32 s[50:51], v39, v45
    s_nop 0
    v_addc_co_u32 v46, vcc, 0, v46, s[48:49]
    v_addc_co_u32 v47, vcc, 0, v47, s[50:51]
    v_cmp_gt_u32 s[48:49], v40, v44
    v_cmp_gt_u32 s[50:51], v40, v45
    s_nop 0
    v_addc_co_u32 v46, vcc, 0, v46, s[48:49]
    v_addc_co_u32 v47, vcc, 0, v47, s[50:51]
    v_cmp_gt_u32 s[48:49], v41, v44
    v_cmp_gt_u32 s[50:51], v41, v45
    s_nop 0
    v_addc_co_u32 v46, vcc, 0, v46, s[48:49]
    v_addc_co_u32 v47, vcc, 0, v47, s[50:51]
    s_waitcnt lgkmcnt(1)
    v_cmp_gt_u32 s[48:49], v48, v44
    v_cmp_gt_u32 s[50:51], v48, v45
    s_nop 0
    v_addc_co_u32 v46, vcc, 0, v46, s[48:49]
    v_addc_co_u32 v47, vcc, 0, v47, s[50:51]
    v_cmp_gt_u32 s[48:49], v49, v44
    v_cmp_gt_u32 s[50:51], v49, v45
    s_nop 0
    v_addc_co_u32 v46, vcc, 0, v46, s[48:49]
    v_addc_co_u32 v47, vcc, 0, v47, s[50:51]
    v_cmp_gt_u32 s[48:49], v50, v44
    v_cmp_gt_u32 s[50:51], v50, v45
    s_nop 0
    v_addc_co_u32 v46, vcc, 0, v46, s[48:49]
    v_addc_co_u32 v47, vcc, 0, v47, s[50:51]
    v_cmp_gt_u32 s[48:49], v51, v44
    v_cmp_gt_u32 s[50:51], v51, v45
    s_nop 0
    v_addc_co_u32 v46, vcc, 0, v46, s[48:49]
    v_addc_co_u32 v47, vcc, 0, v47, s[50:51]
    s_waitcnt lgkmcnt(0)
    v_cmp_gt_u32 s[48:49], v52, v44
    v_cmp_gt_u32 s[50:51], v52, v45
    s_nop 0
    v_addc_co_u32 v46, vcc, 0, v46, s[48:49]
    v_addc_co_u32 v47, vcc, 0, v47, s[50:51]
    v_cmp_gt_u32 s[48:49], v53, v44
    v_cmp_gt_u32 s[50:51], v53, v45
    s_nop 0
    v_addc_co_u32 v46, vcc, 0, v46, s[48:49]
    v_addc_co_u32 v47, vcc, 0, v47, s[50:51]
    v_cmp_gt_u32 s[48:49], v54, v44
    v_cmp_gt_u32 s[50:51], v54, v45
    s_nop 0
    v_addc_co_u32 v46, vcc, 0, v46, s[48:49]
    v_addc_co_u32 v47, vcc, 0, v47, s[50:51]
    v_cmp_gt_u32 s[48:49], v55, v44
    v_cmp_gt_u32 s[50:51], v55, v45
    s_nop 0
    v_addc_co_u32 v46, vcc, 0, v46, s[48:49]
    v_addc_co_u32 v47, vcc, 0, v47, s[50:51]
    ds_add_u32 v21, v46 offset:2560
    ds_add_u32 v21, v47 offset:2816
    s_waitcnt lgkmcnt(0)
    s_barrier
    ds_read_b32 v46, v21 offset:2560
    ds_read_b32 v47, v21 offset:2816
    s_waitcnt lgkmcnt(1)
    v_cmp_gt_u32 vcc, 8, v46
    v_cmp_ne_u32 s[64:65], 0, v44
    v_lshlrev_b32 v46, 2, v46
    s_and_b64 exec, vcc, s[64:65]
    ds_write_b32 v46, v44 offset:64
    s_mov_b64 exec, -1
    s_waitcnt lgkmcnt(1)
    v_cmp_gt_u32 vcc, 8, v47
    v_cmp_ne_u32 s[64:65], 0, v45
    v_lshlrev_b32 v47, 2, v47
    s_and_b64 exec, vcc, s[64:65]
    ds_write_b32 v47, v45 offset:64
    s_mov_b64 exec, -1
    s_waitcnt lgkmcnt(0)
    s_branch k_tk_done
k_tk_slow:
    s_waitcnt lgkmcnt(0)
    v_cmp_ge_u32 s[48:49], v12, v30
    v_cmp_ge_u32 s[50:51], v13, v30
    v_cmp_ge_u32 s[52:53], v14, v30
    v_cmp_ge_u32 s[54:55], v15, v30
    v_mov_b32 v31, s63
    s_mov_b64 exec, 1
    ds_add_rtn_u32 v33, v20, v31 offset:640
    s_mov_b64 exec, -1
    s_waitcnt lgkmcnt(0)
    v_readfirstlane_b32 s64, v33
    v_mbcnt_lo_u32_b32 v34, s48, 0
    v_mbcnt_hi_u32_b32 v34, s49, v34
    v_add_lshl_u32 v34, v34, s64, 2
    s_mov_b64 exec, s[48:49]
    ds_write_b32 v34, v12 offset:26624
    s_mov_b64 exec, -1
    v_mbcnt_lo_u32_b32 v35, s50, 0
    v_mbcnt_hi_u32_b32 v35, s51, v35
    s_add_u32 s65, s64, s60
    v_add_lshl_u32 v35, v35, s65, 2
    s_mov_b64 exec, s[50:51]
    ds_write_b32 v35, v13 offset:26624
    s_mov_b64 exec, -1
    v_mbcnt_lo_u32_b32 v36, s52, 0
    v_mbcnt_hi_u32_b32 v36, s53, v36
    s_add_u32 s65, s64, s61
    v_add_lshl_u32 v36, v36, s65, 2
    s_mov_b64 exec, s[52:53]
    ds_write_b32 v36, v14 offset:26624
    s_mov_b64 exec, -1
    v_mbcnt_lo_u32_b32 v37, s54, 0
    v_mbcnt_hi_u32_b32 v37, s55, v37
    s_add_u32 s65, s64, s62
    v_add_lshl_u32 v37, v37, s65, 2
    s_mov_b64 exec, s[54:55]
    ds_write_b32 v37, v15 offset:26624
    s_mov_b64 exec, -1
    s_waitcnt lgkmcnt(0)
    s_barrier
    ds_read_b32 v30, v20 offset:640
    s_waitcnt lgkmcnt(0)
    v_readfirstlane_b32 s60, v30
    s_mov_b32 s61, 0
k_tk_chunk:
    v_add_u32 v31, s61, v0
    v_lshlrev_b32 v33, 2, v31
    ds_read_b32 v30, v33 offset:26624
    v_mov_b32 v33, 0
    s_mov_b32 s62, 0
    v_mov_b32 v32, 0
k_tk_scan:
    ds_read_b128 v[34:37], v32 offset:26624
    s_sub_u32 s63, s60, s62
    s_waitcnt lgkmcnt(0)
    v_cmp_gt_u32 vcc, v34, v30
    s_cmp_gt_u32 s63, 0
    s_cselect_b64 vcc, vcc, 0
    v_addc_co_u32 v33, vcc, 0, v33, vcc
    v_cmp_gt_u32 vcc, v35, v30
    s_cmp_gt_u32 s63, 1
    s_cselect_b64 vcc, vcc, 0
    v_addc_co_u32 v33, vcc, 0, v33, vcc
    v_cmp_gt_u32 vcc, v36, v30
    s_cmp_gt_u32 s63, 2
    s_cselect_b64 vcc, vcc, 0
    v_addc_co_u32 v33, vcc, 0, v33, vcc
    v_cmp_gt_u32 vcc, v37, v30
    s_cmp_gt_u32 s63, 3
    s_cselect_b64 vcc, vcc, 0
    v_addc_co_u32 v33, vcc, 0, v33, vcc
    v_add_u32 v32, 16, v32
    s_add_u32 s62, s62, 4
    s_cmp_lt_u32 s62, s60
    s_cbranch_scc1 k_tk_scan
    v_cmp_gt_u32 vcc, s60, v31
    v_cmp_gt_u32 s[64:65], 8, v33
    s_nop 0
    s_and_b64 vcc, vcc, s[64:65]
    v_lshlrev_b32 v33, 2, v33
    s_mov_b64 exec, vcc
    ds_write_b32 v33, v30 offset:64
    s_mov_b64 exec, -1
    s_add_u32 s61, s61, 512
    s_cmp_lt_u32 s61, s60
    s_cbranch_scc1 k_tk_chunk
    s_waitcnt lgkmcnt(0)
    s_barrier
    s_branch k_tk_done
k_code_end:

.section .rodata,"a"
.p2align 6
.amdhsa_kernel adaLN_cond__ssm_conv_h3__moe_arch_mod__prompt_kernel
  .amdhsa_next_free_vgpr 168
  .amdhsa_next_free_sgpr 102
  .amdhsa_accum_offset 168
  .amdhsa_group_segment_fixed_size 0
  .amdhsa_kernarg_size 128
  .amdhsa_user_sgpr_count 2
  .amdhsa_user_sgpr_kernarg_segment_ptr 1
  .amdhsa_system_sgpr_workgroup_id_x 1
  .amdhsa_float_denorm_mode_32 3
.end_amdhsa_kernel
```
